```python
import torch

def _softmax(x, axis=-1):
    return torch.softmax(x, dim=axis)

def _gelu(x):
    return torch.nn.functional.gelu(x, approximate='tanh')

def _silu(x):
    return torch.nn.functional.silu(x)

def _sigmoid(x):
    return torch.sigmoid(x)

def _layernorm(x, axis=-1, eps=1e-05):
    m = x.mean(dim=axis, keepdim=True)
    v = x.var(dim=axis, keepdim=True, unbiased=False)
    return (x - m) / torch.sqrt(v + eps)

def _scatter_add(tgt, idx, src, axis=0):
    return tgt.clone().index_add_(axis, idx, src)

def _segment_sum(src, seg, n):
    out = torch.zeros((n,) + src.shape[1:], dtype=src.dtype)
    return out.index_add_(0, seg, src)

def _pad(x, pw):
    flat = tuple((v for pair in reversed(pw) for v in pair))
    return torch.nn.functional.pad(x, flat)
kernel_name = 'gather_scatter__tensor_product_equiv_equiformer__graph'

def setup_inputs():

    _w = lambda a: (lambda t: t.to(torch.bfloat16) if t.is_floating_point() else t)(torch.as_tensor(a))
    N, deg, C, De = (12500, 64, 64, max(4, 1))
    E = N * deg
    src = (lambda lo, hi, *s: torch.randint(lo, hi, s))(0, N, E).to(torch.int64)
    dst = (lambda lo, hi, *s: torch.randint(lo, hi, s))(0, N, E).to(torch.int64)
    rvec = (lambda *s: torch.randn(*s, dtype=torch.bfloat16) * 0.05)(E, 3).to(float)
    rn = (torch.linalg.norm(rvec, dim=-1, keepdim=True) + 1e-06).to(float)
    rhat = (rvec / rn).to(float)
    eps = torch.zeros((3, 3, 3), dtype=float)
    eps[0, 1, 2] = eps[1, 2, 0] = eps[2, 0, 1] = 1.0
    eps[0, 2, 1] = eps[2, 1, 0] = eps[1, 0, 2] = -1.0
    return {'x': _w((lambda *s: torch.randn(*s, dtype=torch.bfloat16) * 0.4)(N, 4 * C).to(float)), 'rhat': _w(rhat), 'e_attr': _w((lambda *s: torch.randn(*s, dtype=torch.bfloat16) * 0.4)(E, De).to(float)), 'src': _w(src), 'dst': _w(dst), 'w_rad': _w((lambda *s: torch.randn(*s, dtype=torch.bfloat16) * 0.4)(De, 5 * C).to(float)), 'w_si0': _w((lambda *s: torch.randn(*s, dtype=torch.bfloat16) * 0.4)(2 * C, C).to(float)), 'w_si1': _w((lambda *s: torch.randn(*s, dtype=torch.bfloat16) * 0.05)(3 * C, C).to(float)), 'cg_eps': _w(eps)}

def reference(x, rhat, e_attr, src, dst, w_rad, w_si0, w_si1, cg_eps):
    N = x.shape[0]
    C = w_si0.shape[1]
    E = rhat.shape[0]
    x0 = x[:, :C].clone()
    x1 = x[:, C:].reshape(N, 3, C)
    R = (e_attr @ w_rad).reshape(E, 5, C)
    f0 = x0[src]
    f1 = x1[src]
    Y1 = rhat
    p00_0 = f0 * R[:, 0, :]
    p11_0 = torch.einsum('ejc,ej->ec', f1, Y1) * R[:, 1, :]
    p01_1 = torch.einsum('ec,ej->ejc', f0, Y1) * R[:, 2, :][:, None, :]
    p10_1 = f1 * R[:, 3, :][:, None, :]
    p11_1 = torch.einsum('ijk,ekc,ej->eic', cg_eps, f1, Y1) * R[:, 4, :][:, None, :]
    m0 = torch.concatenate([p00_0, p11_0], axis=-1) @ w_si0
    m1 = torch.einsum('ejp,pc->ejc', torch.concatenate([p01_1, p10_1, p11_1], axis=-1), w_si1)
    agg0 = _segment_sum(m0, dst, N)
    agg1 = _segment_sum(m1.reshape(E, 3 * C), dst, N).reshape(N, 3, C)
    gate = _sigmoid(agg0)
    out1 = agg1 * gate[:, None, :]
    return torch.concatenate([agg0, out1.reshape(N, 3 * C)], axis=-1)
```

```asm
; @launch grid=(256,1,1) block=(512,1,1) lds=163648
.amdgcn_target "amdgcn-amd-amdhsa--gfx950"
.text
.globl gather_scatter__tensor_product_equiv_equiformer__graph_kernel
.p2align 8
.type gather_scatter__tensor_product_equiv_equiformer__graph_kernel,@function
gather_scatter__tensor_product_equiv_equiformer__graph_kernel:
    s_cmp_ge_u32 s2, 256
    s_cbranch_scc1 L_exit
    s_load_dwordx16 s[56:71], s[0:1], 8
    s_load_dwordx2 s[4:5], s[0:1], 0
    s_load_dwordx2 s[12:13], s[0:1], 72
    s_load_dwordx4 s[72:75], s[0:1], 80
    s_mul_i32 s3, s2, 3136
    v_lshl_add_u32 v1, v0, 1, s3
    v_lshrrev_b32 v4, 6, v0
    v_and_b32 v5, 63, v0
    s_mov_b32 s48, 799998
    v_readfirstlane_b32 s77, v4
    v_cmp_ge_u32 s[20:21], s48, v1
    v_min_u32 v128, s48, v1
    v_lshlrev_b32 v56, 2, v128
    v_add_u32 v1, 1024, v1
    v_cmp_ge_u32 s[22:23], s48, v1
    v_min_u32 v129, s48, v1
    v_lshlrev_b32 v57, 2, v129
    v_add_u32 v1, 1024, v1
    v_cmp_ge_u32 s[24:25], s48, v1
    v_min_u32 v130, s48, v1
    v_lshlrev_b32 v58, 2, v130
    v_add_u32 v1, 1024, v1
    v_cmp_ge_u32 s[26:27], s48, v1
    v_min_u32 v131, s48, v1
    v_lshlrev_b32 v59, 2, v131
    s_cmp_lg_u32 s77, 0
    s_cselect_b32 s26, 0, s26
    s_mov_b32 s27, 0
    s_waitcnt lgkmcnt(0)
    s_cbranch_scc1 L_no3
    s_mov_b64 exec, 0xffffffff
    global_load_dwordx2 v[14:15], v59, s[62:63] nt
    v_mul_u32_u24 v1, 6, v131
    v_lshlrev_b32 v2, 3, v131
    global_load_dwordx2 v[22:23], v59, s[60:61] nt
    global_load_dwordx3 v[52:54], v1, s[56:57] nt
    global_load_dwordx4 v[36:39], v2, s[58:59] nt
    s_mov_b64 exec, -1
L_no3:
    global_load_dwordx2 v[8:9], v56, s[62:63] nt
    global_load_dwordx2 v[10:11], v57, s[62:63] nt
    global_load_dwordx2 v[12:13], v58, s[62:63] nt
    s_lshl_b32 s49, s2, 3
    s_or_b32 s49, s49, s77
    s_cmp_lg_u32 s49, 7
    s_cbranch_scc1 L_nononce
    s_memrealtime s[100:101]
    v_mov_b32 v6, 0
    s_mov_b64 exec, 1
    s_waitcnt lgkmcnt(0)
    s_or_b32 s49, s100, 1
    v_mov_b32 v208, s49
    global_store_dword v6, v208, s[72:73] sc1
    s_mov_b64 exec, -1
L_nononce:
    s_mov_b32 s6, 6400000
    s_mov_b32 s7, 0x20000
    s_mov_b32 s8, s74
    s_mov_b32 s9, s75
    s_mov_b32 s10, 14204928
    s_mov_b32 s11, 0x20000
    s_mov_b32 s14, 6400000
    s_mov_b32 s15, 0x20000
    s_add_u32 s96, s74, 33554432
    s_addc_u32 s97, s75, 0
    s_mov_b32 s98, 75497472
    s_mov_b32 s99, 0x20000
    v_lshlrev_b32 v6, 2, v0
    v_mov_b32 v4, 0
    v_cmp_gt_u32 vcc, 256, v0
    s_mov_b64 exec, vcc
    ds_write_b32 v6, v4 offset:12032
    ds_write_b32 v6, v4 offset:0
    s_mov_b64 exec, -1
    s_waitcnt lgkmcnt(0)
    s_barrier
    v_mul_u32_u24 v1, 6, v128
    v_lshlrev_b32 v2, 3, v128
    global_load_dwordx2 v[16:17], v56, s[60:61] nt
    global_load_dwordx3 v[40:42], v1, s[56:57] nt
    global_load_dwordx4 v[24:27], v2, s[58:59] nt
    v_mul_u32_u24 v1, 6, v129
    v_lshlrev_b32 v2, 3, v129
    global_load_dwordx2 v[18:19], v57, s[60:61] nt
    global_load_dwordx3 v[44:46], v1, s[56:57] nt
    global_load_dwordx4 v[28:31], v2, s[58:59] nt
    v_mul_u32_u24 v1, 6, v130
    v_lshlrev_b32 v2, 3, v130
    global_load_dwordx2 v[20:21], v58, s[60:61] nt
    global_load_dwordx3 v[48:50], v1, s[56:57] nt
    global_load_dwordx4 v[32:35], v2, s[58:59] nt
    s_mov_b32 s16, 512
    s_mov_b32 s17, 0x05040100
    s_mov_b32 s18, 0x07060302
    s_mov_b32 s19, 0xffff0000
    s_mov_b32 s48, 5350
    v_mov_b32 v6, 1
    s_waitcnt vmcnt(9)
    s_mov_b64 exec, s[20:21]
    s_cbranch_execz L_nohist
    v_mul_u32_u24 v56, s48, v8
    v_lshrrev_b32 v56, 18, v56
    v_mul_u32_u24 v64, 49, v56
    v_lshlrev_b32 v56, 2, v56
    ds_add_rtn_u32 v72, v56, v6 offset:12032
    v_sub_u32 v64, v8, v64
    v_lshlrev_b32 v64, 2, v64
    v_mul_u32_u24 v57, s48, v9
    v_lshrrev_b32 v57, 18, v57
    v_mul_u32_u24 v65, 49, v57
    v_lshlrev_b32 v57, 2, v57
    ds_add_rtn_u32 v73, v57, v6 offset:12032
    v_sub_u32 v65, v9, v65
    v_lshlrev_b32 v65, 2, v65
    s_mov_b64 exec, s[22:23]
    s_cbranch_execz L_nohist
    v_mul_u32_u24 v58, s48, v10
    v_lshrrev_b32 v58, 18, v58
    v_mul_u32_u24 v66, 49, v58
    v_lshlrev_b32 v58, 2, v58
    ds_add_rtn_u32 v74, v58, v6 offset:12032
    v_sub_u32 v66, v10, v66
    v_lshlrev_b32 v66, 2, v66
    v_mul_u32_u24 v59, s48, v11
    v_lshrrev_b32 v59, 18, v59
    v_mul_u32_u24 v67, 49, v59
    v_lshlrev_b32 v59, 2, v59
    ds_add_rtn_u32 v75, v59, v6 offset:12032
    v_sub_u32 v67, v11, v67
    v_lshlrev_b32 v67, 2, v67
    s_mov_b64 exec, s[24:25]
    s_cbranch_execz L_nohist
    v_mul_u32_u24 v60, s48, v12
    v_lshrrev_b32 v60, 18, v60
    v_mul_u32_u24 v68, 49, v60
    v_lshlrev_b32 v60, 2, v60
    ds_add_rtn_u32 v76, v60, v6 offset:12032
    v_sub_u32 v68, v12, v68
    v_lshlrev_b32 v68, 2, v68
    v_mul_u32_u24 v61, s48, v13
    v_lshrrev_b32 v61, 18, v61
    v_mul_u32_u24 v69, 49, v61
    v_lshlrev_b32 v61, 2, v61
    ds_add_rtn_u32 v77, v61, v6 offset:12032
    v_sub_u32 v69, v13, v69
    v_lshlrev_b32 v69, 2, v69
    s_mov_b64 exec, s[26:27]
    s_cbranch_execz L_nohist
    v_mul_u32_u24 v62, s48, v14
    v_lshrrev_b32 v62, 18, v62
    v_mul_u32_u24 v70, 49, v62
    v_lshlrev_b32 v62, 2, v62
    ds_add_rtn_u32 v78, v62, v6 offset:12032
    v_sub_u32 v70, v14, v70
    v_lshlrev_b32 v70, 2, v70
    v_mul_u32_u24 v63, s48, v15
    v_lshrrev_b32 v63, 18, v63
    v_mul_u32_u24 v71, 49, v63
    v_lshlrev_b32 v63, 2, v63
    ds_add_rtn_u32 v79, v63, v6 offset:12032
    v_sub_u32 v71, v15, v71
    v_lshlrev_b32 v71, 2, v71
L_nohist:
    s_mov_b64 exec, -1
    v_lshlrev_b32 v6, 4, v0
    v_mov_b32 v88, -1
    v_mov_b32 v89, -1
    v_mov_b32 v90, -1
    v_mov_b32 v91, -1
    v_cmp_gt_u32 vcc, 432, v0
    s_mov_b64 exec, vcc
    ds_write_b128 v6, v[88:91] offset:1024
    s_mov_b64 exec, -1
    s_waitcnt lgkmcnt(0)
    s_barrier
    s_cmp_lg_u32 s77, 7
    s_cbranch_scc1 L_noscan
    v_lshlrev_b32 v6, 4, v5
    ds_read_b128 v[88:91], v6 offset:12032
    s_waitcnt lgkmcnt(0)
    v_add_u32 v1, v88, v89
    v_add3_u32 v2, v90, v91, v1
    v_mov_b32 v92, v2
    s_nop 1
    v_add_u32_dpp v92, v92, v92 row_shr:1 row_mask:0xf bank_mask:0xf bound_ctrl:0
    s_nop 1
    v_add_u32_dpp v92, v92, v92 row_shr:2 row_mask:0xf bank_mask:0xf bound_ctrl:0
    s_nop 1
    v_add_u32_dpp v92, v92, v92 row_shr:4 row_mask:0xf bank_mask:0xf bound_ctrl:0
    s_nop 1
    v_add_u32_dpp v92, v92, v92 row_shr:8 row_mask:0xf bank_mask:0xf bound_ctrl:0
    s_nop 1
    v_add_u32_dpp v92, v92, v92 row_bcast:15 row_mask:0xa bank_mask:0xf
    s_nop 1
    v_add_u32_dpp v92, v92, v92 row_bcast:31 row_mask:0xc bank_mask:0xf
    v_sub_u32 v92, v92, v2
    v_add_u32 v93, v92, v88
    v_add_u32 v94, v92, v1
    v_add_u32 v95, v94, v90
    ds_write_b128 v6, v[92:95] offset:13056
    v_mov_b32 v1, 0
    global_load_dword v210, v1, s[72:73] sc1
    s_waitcnt lgkmcnt(0)
L_noscan:
    s_barrier
    ds_read_b32 v80, v56 offset:13056
    ds_read_b32 v81, v57 offset:13056
    ds_read_b32 v82, v58 offset:13056
    ds_read_b32 v83, v59 offset:13056
    ds_read_b32 v84, v60 offset:13056
    ds_read_b32 v85, v61 offset:13056
    ds_read_b32 v86, v62 offset:13056
    ds_read_b32 v87, v63 offset:13056
    v_and_b32 v2, 255, v0
    v_lshlrev_b32 v2, 2, v2
    ds_read_b32 v218, v2 offset:12032
    ds_read_b32 v219, v2 offset:13056
    s_waitcnt lgkmcnt(2)
    v_add_u32 v80, v80, v72
    v_lshlrev_b32 v56, 4, v80
    v_add_u32 v80, 64256, v80
    v_add_u32 v56, 14080, v56
    v_add_u32 v81, v81, v73
    v_lshlrev_b32 v57, 4, v81
    v_add_u32 v81, 64256, v81
    v_add_u32 v57, 14080, v57
    v_add_u32 v82, v82, v74
    v_lshlrev_b32 v58, 4, v82
    v_add_u32 v82, 64256, v82
    v_add_u32 v58, 14080, v58
    v_add_u32 v83, v83, v75
    v_lshlrev_b32 v59, 4, v83
    v_add_u32 v83, 64256, v83
    v_add_u32 v59, 14080, v59
    v_add_u32 v84, v84, v76
    v_lshlrev_b32 v60, 4, v84
    v_add_u32 v84, 64256, v84
    v_add_u32 v60, 14080, v60
    v_add_u32 v85, v85, v77
    v_lshlrev_b32 v61, 4, v85
    v_add_u32 v85, 64256, v85
    v_add_u32 v61, 14080, v61
    v_add_u32 v86, v86, v78
    v_lshlrev_b32 v62, 4, v86
    v_add_u32 v86, 64256, v86
    v_add_u32 v62, 14080, v62
    v_add_u32 v87, v87, v79
    v_lshlrev_b32 v63, 4, v87
    v_add_u32 v87, 64256, v87
    v_add_u32 v63, 14080, v63
    s_waitcnt lgkmcnt(0)
    v_lshl_or_b32 v216, v218, 16, v219
    v_lshlrev_b32 v218, 1, v2
    s_mov_b64 exec, s[20:21]
    ds_write_b8 v80, v64
    ds_write_b8 v81, v65
    s_mov_b64 exec, s[22:23]
    ds_write_b8 v82, v66
    ds_write_b8 v83, v67
    s_mov_b64 exec, s[24:25]
    ds_write_b8 v84, v68
    ds_write_b8 v85, v69
    s_mov_b64 exec, s[26:27]
    ds_write_b8 v86, v70
    ds_write_b8 v87, v71
    s_cbranch_execz L_nos3
    v_alignbit_b32 v100, v54, v53, 16
    v_alignbit_b32 v101, v23, v54, 16
    v_perm_b32 v53, v22, v53, s17
    ds_write2_b64 v63, v[38:39], v[100:101] offset0:0 offset1:1
    ds_write2_b64 v62, v[36:37], v[52:53] offset0:0 offset1:1
L_nos3:
    s_mov_b64 exec, -1
    v_lshlrev_b32 v6, 4, v0
    v_add_u32 v4, 8192, v6
    global_load_dwordx4 v[104:107], v6, s[66:67]
    global_load_dwordx4 v[108:111], v4, s[66:67]
    global_load_dwordx4 v[112:115], v6, s[68:69]
    global_load_dwordx4 v[116:119], v4, s[68:69]
    v_add_u32 v4, 16384, v6
    global_load_dwordx4 v[120:123], v4, s[68:69]
    s_mov_b64 exec, s[20:21]
    s_cbranch_execz L_noscat0
    s_waitcnt vmcnt(11)
    v_alignbit_b32 v88, v42, v41, 16
    v_alignbit_b32 v89, v17, v42, 16
    v_perm_b32 v41, v16, v41, s17
    ds_write2_b64 v57, v[26:27], v[88:89] offset0:0 offset1:1
    ds_write2_b64 v56, v[24:25], v[40:41] offset0:0 offset1:1
    s_mov_b64 exec, s[22:23]
    s_cbranch_execz L_noscat0
    s_waitcnt vmcnt(8)
    v_alignbit_b32 v92, v46, v45, 16
    v_alignbit_b32 v93, v19, v46, 16
    v_perm_b32 v45, v18, v45, s17
    ds_write2_b64 v59, v[30:31], v[92:93] offset0:0 offset1:1
    ds_write2_b64 v58, v[28:29], v[44:45] offset0:0 offset1:1
    s_mov_b64 exec, s[24:25]
    s_cbranch_execz L_noscat0
    s_waitcnt vmcnt(5)
    v_alignbit_b32 v96, v50, v49, 16
    v_alignbit_b32 v97, v21, v50, 16
    v_perm_b32 v49, v20, v49, s17
    ds_write2_b64 v61, v[34:35], v[96:97] offset0:0 offset1:1
    ds_write2_b64 v60, v[32:33], v[48:49] offset0:0 offset1:1
L_noscat0:
    s_mov_b64 exec, -1
    s_sub_u32 s49, s77, 2
    s_cmp_ge_u32 s49, 2
    s_cbranch_scc1 L_noscat
    s_lshl_b32 s49, s49, 1
    v_and_b32 v184, 15, v0
    v_bfe_u32 v185, v0, 4, 2
    v_lshrrev_b32 v186, 3, v184
    v_add_u32 v186, s49, v186
    v_mov_b32 v125, 4
    v_cmp_eq_u32 vcc, v185, v186
    v_cmp_eq_u32 s[28:29], 0, v186
    v_cmp_eq_u32 s[30:31], 0, v185
    v_cndmask_b32 v125, v125, 1, vcc
    v_sub_u32 v187, v186, v185
    v_cndmask_b32 v125, v125, 2, s[28:29]
    s_and_b64 s[32:33], s[28:29], s[30:31]
    v_cndmask_b32 v125, v125, 3, s[30:31]
    v_cmp_eq_u32 vcc, -1, v187
    v_cmp_eq_u32 s[28:29], 2, v187
    v_cndmask_b32 v125, v125, 0, s[32:33]
    s_or_b64 s[28:29], s[28:29], vcc
    v_cmp_eq_u32 vcc, 4, v125
    s_and_b64 vcc, s[28:29], vcc
    v_mov_b32 v187, 0x80008000
    v_lshlrev_b32 v125, 7, v125
    v_cndmask_b32 v124, 0, v187, vcc
    v_and_b32 v187, 7, v184
    v_lshl_add_u32 v125, v187, 4, v125
    global_load_dwordx4 v[168:171], v125, s[64:65] offset:0
    global_load_dwordx4 v[172:175], v125, s[64:65] offset:640
    global_load_dwordx4 v[176:179], v125, s[64:65] offset:1280
    global_load_dwordx4 v[180:183], v125, s[64:65] offset:1920
L_noscat:
    s_mov_b64 exec, -1
    s_cmp_lg_u32 s77, 7
    s_cbranch_scc1 L_nonce3
    v_mov_b32 v2, 0
    s_mov_b32 s49, 0
    s_waitcnt vmcnt(5)
L_tag:
    v_readfirstlane_b32 s48, v210
    s_add_u32 s49, s49, 1
    s_cmp_lg_u32 s48, 0
    s_cbranch_scc1 L_tagd
    s_cmp_ge_u32 s49, 0x40000
    s_cbranch_scc1 L_tagd
    global_load_dword v210, v2, s[72:73] sc1
    s_waitcnt vmcnt(0)
    s_branch L_tag
L_tagd:
    v_mov_b32 v1, s48
    ds_write_b32 v2, v1 offset:576
L_nonce3:
    v_lshlrev_b32 v6, 4, v0
    v_add_u32 v4, 64256, v6
    s_mul_i32 s48, s2, 50176
    s_add_u32 s49, s3, 12845056
    v_mov_b32 v1, 0
    s_waitcnt lgkmcnt(0)
    s_barrier
    ds_read_b32 v217, v1 offset:576
    ds_read_b128 v[40:43], v4
    ds_read_b128 v[44:47], v6 offset:63232
    ds_read_b128 v[8:11], v6 offset:14080
    ds_read_b128 v[12:15], v6 offset:22272
    ds_read_b128 v[16:19], v6 offset:30464
    ds_read_b128 v[20:23], v6 offset:38656
    ds_read_b128 v[24:27], v6 offset:46848
    ds_read_b128 v[28:31], v6 offset:55040
    s_cmp_ge_u32 s77, 4
    s_cbranch_scc1 L_norow
    s_lshl_b32 s50, s2, 11
    s_add_u32 s50, s50, 13647872
    s_mov_b32 s83, 0xf000f000
    s_waitcnt lgkmcnt(8)
    v_and_or_b32 v216, v217, s83, v216
    buffer_store_dwordx2 v[216:217], v218, s[8:11], s50 offen sc1
L_norow:
    s_waitcnt lgkmcnt(5)
    buffer_store_dwordx4 v[8:11], v6, s[8:11], s48 offen sc1
    s_add_u32 s48, s48, 8192
    s_waitcnt lgkmcnt(4)
    buffer_store_dwordx4 v[12:15], v6, s[8:11], s48 offen sc1
    s_add_u32 s48, s48, 8192
    s_waitcnt lgkmcnt(3)
    buffer_store_dwordx4 v[16:19], v6, s[8:11], s48 offen sc1
    s_add_u32 s48, s48, 8192
    s_waitcnt lgkmcnt(2)
    buffer_store_dwordx4 v[20:23], v6, s[8:11], s48 offen sc1
    s_add_u32 s48, s48, 8192
    s_waitcnt lgkmcnt(1)
    buffer_store_dwordx4 v[24:27], v6, s[8:11], s48 offen sc1
    s_add_u32 s48, s48, 8192
    s_waitcnt lgkmcnt(0)
    buffer_store_dwordx4 v[28:31], v6, s[8:11], s48 offen sc1
    s_add_u32 s48, s48, 8192
    v_cmp_gt_u32 vcc, 196, v0
    s_mov_b64 exec, vcc
    s_cbranch_execz L_nokey
    buffer_store_dwordx4 v[40:43], v6, s[8:11], s49 offen sc1
    s_cmp_lg_u32 s77, 0
    s_cbranch_scc1 L_nokey
    buffer_store_dwordx4 v[44:47], v6, s[8:11], s48 offen sc1
L_nokey:
    s_mov_b64 exec, -1
    s_waitcnt vmcnt(6)
    v_and_b32 v4, 15, v0
    v_lshlrev_b32 v248, 4, v4
    v_bfe_u32 v1, v0, 4, 2
    v_bfe_u32 v2, v0, 2, 2
    v_lshl_add_u32 v249, v1, 3, v2
    v_and_b32 v4, 3, v0
    v_and_b32 v2, 1, v4
    v_lshlrev_b32 v2, 3, v2
    v_lshl_add_u32 v250, v249, 4, v2
    v_lshrrev_b32 v4, 1, v4
    v_mul_u32_u24 v4, 55360, v4
    v_add_u32 v250, v250, v4
    v_add_u32 v250, 12032, v250
    v_add_u32 v4, 69376, v6
    ds_write_b128 v4, v[104:107] offset:0
    ds_write_b128 v4, v[108:111] offset:8192
    ds_write_b128 v4, v[112:115] offset:16384
    ds_write_b128 v4, v[116:119] offset:24576
    ds_write_b128 v4, v[120:123] offset:32768
    s_sub_u32 s48, s77, 2
    s_cmp_ge_u32 s48, 2
    s_cbranch_scc1 L_now2
    s_mul_i32 s48, s48, -102400
    s_add_u32 s48, s48, 110336
    v_lshl_add_u32 v4, v5, 4, s48
    v_xor_b32 v168, v124, v168
    v_xor_b32 v169, v124, v169
    v_xor_b32 v170, v124, v170
    v_xor_b32 v171, v124, v171
    v_xor_b32 v172, v124, v172
    v_xor_b32 v173, v124, v173
    v_xor_b32 v174, v124, v174
    v_xor_b32 v175, v124, v175
    v_xor_b32 v176, v124, v176
    v_xor_b32 v177, v124, v177
    v_xor_b32 v178, v124, v178
    v_xor_b32 v179, v124, v179
    v_xor_b32 v180, v124, v180
    v_xor_b32 v181, v124, v181
    v_xor_b32 v182, v124, v182
    v_xor_b32 v183, v124, v183
    ds_write_b128 v4, v[168:171] offset:0
    ds_write_b128 v4, v[172:175] offset:1024
    ds_write_b128 v4, v[176:179] offset:2048
    ds_write_b128 v4, v[180:183] offset:3072
L_now2:
    s_waitcnt lgkmcnt(0)
    v_readfirstlane_b32 s78, v217
    s_and_b32 s79, s2, 7
    s_lshl_b32 s79, s79, 5
    s_lshr_b32 s50, s2, 3
    s_or_b32 s79, s79, s50
    v_lshrrev_b32 v2, 1, v0
    v_lshlrev_b32 v2, 2, v2
    s_lshr_b32 s50, s79, 3
    s_lshl_b32 s50, s50, 10
    s_add_u32 s50, s50, 14172160
    v_lshlrev_b32 v4, 10, v5
    s_lshl_b32 s48, s79, 2
    s_add_u32 s48, s48, 14172160
    s_waitcnt vmcnt(0)
    s_barrier
    s_cmp_lg_u32 s77, 0
    s_cbranch_scc1 L_noflag
    s_mov_b64 exec, 0xffffffff
    buffer_store_dword v217, v4, s[8:11], s48 offen sc1
    s_mov_b64 exec, -1
L_noflag:
    v_mov_b32 v240, v2
    s_mov_b32 s70, s50
    v_bfe_u32 v2, v0, 1, 5
    v_lshl_add_u32 v2, v2, 3, s77
    v_lshlrev_b32 v2, 11, v2
    s_lshl_b32 s50, s79, 3
    s_add_u32 s50, s50, 13647872
    buffer_load_dwordx2 v[72:73], v2, s[8:11], s50 offen sc1
    s_lshr_b32 s48, s77, 2
    s_and_b32 s49, s77, 1
    s_lshl_b32 s49, s49, 3
    s_lshl_b32 s83, s48, 6
    s_add_u32 s49, s49, s83
    s_and_b32 s83, s77, 2
    s_lshl_b32 s83, s83, 11
    s_add_u32 s49, s49, s83
    s_add_u32 s49, s49, 69376
    v_and_b32 v4, 3, v0
    v_lshlrev_b32 v4, 4, v4
    v_lshl_add_u32 v4, v249, 7, v4
    v_add_u32 v4, s49, v4
    s_mul_i32 s48, s48, 20
    s_and_b32 s83, s77, 3
    s_add_u32 s48, s48, s83
    s_lshl_b32 s48, s48, 10
    s_add_u32 s48, s48, 122688
    v_lshl_add_u32 v6, v5, 4, s48
    v_lshlrev_b32 v1, 4, v5
    v_add_u32 v1, 110336, v1
    ds_read_b128 v[40:43], v1 offset:0
    ds_read_b128 v[44:47], v1 offset:1024
    ds_read_b128 v[48:51], v1 offset:2048
    ds_read_b128 v[52:55], v1 offset:3072
    ds_read_b64_tr_b16 v[8:9], v4 offset:0
    ds_read_b64_tr_b16 v[10:11], v4 offset:512
    ds_read_b64_tr_b16 v[12:13], v4 offset:8192
    ds_read_b64_tr_b16 v[14:15], v4 offset:8704
    ds_read_b64_tr_b16 v[16:17], v4 offset:16384
    ds_read_b64_tr_b16 v[18:19], v4 offset:16896
    ds_read_b64_tr_b16 v[20:21], v4 offset:24576
    ds_read_b64_tr_b16 v[22:23], v4 offset:25088
    ds_read_b64_tr_b16 v[24:25], v4 offset:32768
    ds_read_b64_tr_b16 v[26:27], v4 offset:33280
    s_waitcnt lgkmcnt(8)
    ds_write_b128 v6, v[8:11] offset:0
    s_waitcnt lgkmcnt(7)
    ds_write_b128 v6, v[12:15] offset:4096
    s_waitcnt lgkmcnt(6)
    ds_write_b128 v6, v[16:19] offset:8192
    s_waitcnt lgkmcnt(5)
    ds_write_b128 v6, v[20:23] offset:12288
    s_waitcnt lgkmcnt(4)
    ds_write_b128 v6, v[24:27] offset:16384
    v_lshlrev_b32 v136, 16, v40
    v_and_b32 v140, s19, v40
    v_lshlrev_b32 v144, 16, v41
    v_and_b32 v148, s19, v41
    v_lshlrev_b32 v152, 16, v42
    v_and_b32 v156, s19, v42
    v_lshlrev_b32 v160, 16, v43
    v_and_b32 v164, s19, v43
    v_lshlrev_b32 v137, 16, v44
    v_and_b32 v141, s19, v44
    v_lshlrev_b32 v145, 16, v45
    v_and_b32 v149, s19, v45
    v_lshlrev_b32 v153, 16, v46
    v_and_b32 v157, s19, v46
    v_lshlrev_b32 v161, 16, v47
    v_and_b32 v165, s19, v47
    v_lshlrev_b32 v138, 16, v48
    v_and_b32 v142, s19, v48
    v_lshlrev_b32 v146, 16, v49
    v_and_b32 v150, s19, v49
    v_lshlrev_b32 v154, 16, v50
    v_and_b32 v158, s19, v50
    v_lshlrev_b32 v162, 16, v51
    v_and_b32 v166, s19, v51
    v_lshlrev_b32 v139, 16, v52
    v_and_b32 v143, s19, v52
    v_lshlrev_b32 v147, 16, v53
    v_and_b32 v151, s19, v53
    v_lshlrev_b32 v155, 16, v54
    v_and_b32 v159, s19, v54
    v_lshlrev_b32 v163, 16, v55
    v_and_b32 v167, s19, v55
    v_mov_b64 v[168:169], 0
    v_mov_b64 v[170:171], 0
    v_mov_b64 v[172:173], 0
    v_mov_b64 v[174:175], 0
    v_mov_b64 v[176:177], 0
    v_mov_b64 v[178:179], 0
    v_mov_b64 v[180:181], 0
    v_mov_b64 v[182:183], 0
    v_mov_b64 v[184:185], 0
    v_mov_b64 v[186:187], 0
    v_mov_b64 v[188:189], 0
    v_mov_b64 v[190:191], 0
    v_mov_b64 v[192:193], 0
    v_mov_b64 v[194:195], 0
    v_mov_b64 v[196:197], 0
    v_mov_b64 v[198:199], 0
    v_mov_b64 v[200:201], 0
    v_mov_b64 v[202:203], 0
    v_mov_b64 v[204:205], 0
    v_mov_b64 v[206:207], 0
    v_mov_b64 v[208:209], 0
    v_mov_b64 v[210:211], 0
    v_mov_b64 v[212:213], 0
    v_mov_b64 v[214:215], 0
    v_mov_b64 v[216:217], 0
    v_mov_b64 v[218:219], 0
    v_mov_b64 v[220:221], 0
    v_mov_b64 v[222:223], 0
    v_mov_b64 v[224:225], 0
    v_mov_b64 v[226:227], 0
    v_mov_b64 v[228:229], 0
    v_mov_b64 v[230:231], 0
    v_mov_b64 v[232:233], 0
    v_mov_b64 v[234:235], 0
    v_mov_b64 v[236:237], 0
    v_mov_b64 v[238:239], 0
    s_mov_b32 s48, 0
    s_mov_b32 s36, 0
    s_mov_b32 s61, 512
L_poll:
    s_waitcnt vmcnt(0)
    v_xor_b32 v4, s78, v72
    v_and_b32 v4, 0xf000f000, v4
    v_xor_b32 v6, s78, v73
    v_or_b32 v4, v4, v6
    v_cmp_ne_u32 vcc, 0, v4
    s_add_u32 s48, s48, 1
    s_cmp_eq_u64 vcc, 0
    s_cbranch_scc1 L_polled
    s_cmp_ge_u32 s48, 0x40000
    s_cbranch_scc1 L_polled
    s_mov_b64 exec, vcc
    buffer_load_dwordx2 v[72:73], v2, s[8:11], s50 offen sc1
    s_branch L_poll
L_polled:
    s_mov_b64 exec, -1
L_decode:
    v_bfe_u32 v1, v0, 1, 5
    v_lshl_add_u32 v1, v1, 3, s77
    buffer_load_dword v241, v240, s[8:11], s70 offen sc1
    v_mul_u32_u24 v1, 3136, v1
    v_bfe_u32 v6, v72, 16, 12
    v_and_b32 v4, 0xfff, v72
    v_add_u32 v1, v1, v4
    v_add_u32 v4, 1, v6
    v_lshrrev_b32 v4, 1, v4
    v_and_b32 v2, 1, v0
    v_cmp_eq_u32 vcc, 1, v2
    v_sub_u32 v6, v6, v4
    s_nop 0
    v_cndmask_b32 v3, v4, v6, vcc
    v_cndmask_b32 v4, 0, v4, vcc
    v_add_u32 v2, v1, v4
    v_mov_b32 v1, v3
    s_nop 1
    v_add_u32_dpp v1, v1, v1 row_shr:1 row_mask:0xf bank_mask:0xf bound_ctrl:0
    s_nop 1
    v_add_u32_dpp v1, v1, v1 row_shr:2 row_mask:0xf bank_mask:0xf bound_ctrl:0
    s_nop 1
    v_add_u32_dpp v1, v1, v1 row_shr:4 row_mask:0xf bank_mask:0xf bound_ctrl:0
    s_nop 1
    v_add_u32_dpp v1, v1, v1 row_shr:8 row_mask:0xf bank_mask:0xf bound_ctrl:0
    s_nop 1
    v_add_u32_dpp v1, v1, v1 row_bcast:15 row_mask:0xa bank_mask:0xf
    s_nop 1
    v_add_u32_dpp v1, v1, v1 row_bcast:31 row_mask:0xc bank_mask:0xf
    s_lshl_b32 s83, s77, 11
    s_add_u32 s83, s83, 14080
    v_readlane_b32 s60, v1, 63
    v_sub_u32 v1, v1, v3
L_round:
    v_sub_u32 v106, s36, v1
    v_max_i32 v105, 0, v106
    v_add_u32 v104, s61, v106
    v_min_i32 v104, v104, v3
    v_sub_u32 v104, v104, v105
    v_sub_u32 v105, v105, v106
    v_lshl_add_u32 v107, v105, 2, s83
    v_add_u32 v106, v2, v106
L_exp:
    v_cmpx_lt_i32 vcc, 0, v104
    ds_write_b32 v107, v106 offset:0
    v_cmpx_lt_i32 vcc, 1, v104
    ds_write_b32 v107, v106 offset:4
    v_cmpx_lt_i32 vcc, 2, v104
    ds_write_b32 v107, v106 offset:8
    v_cmpx_lt_i32 vcc, 3, v104
    ds_write_b32 v107, v106 offset:12
    v_cmpx_lt_i32 vcc, 4, v104
    ds_write_b32 v107, v106 offset:16
    v_cmpx_lt_i32 vcc, 5, v104
    ds_write_b32 v107, v106 offset:20
    v_cmpx_lt_i32 vcc, 6, v104
    ds_write_b32 v107, v106 offset:24
    v_cmpx_lt_i32 vcc, 7, v104
    ds_write_b32 v107, v106 offset:28
    v_cmpx_lt_i32 vcc, 8, v104
    s_cbranch_execz L_expd
    ds_write_b32 v107, v106 offset:32
    v_cmpx_lt_i32 vcc, 9, v104
    ds_write_b32 v107, v106 offset:36
    v_cmpx_lt_i32 vcc, 10, v104
    s_cbranch_execz L_expd
    ds_write_b32 v107, v106 offset:40
    v_cmpx_lt_i32 vcc, 11, v104
    ds_write_b32 v107, v106 offset:44
    v_cmpx_lt_i32 vcc, 12, v104
    v_add_u32 v107, 48, v107
    v_add_u32 v104, -12, v104
    s_cbranch_execnz L_exp
L_expd:
    s_mov_b64 exec, -1
    s_sub_i32 s82, s60, s36
    s_max_i32 s82, s82, 0
    s_cmp_gt_u32 s82, s61
    s_cselect_b32 s62, 1, 0
    s_min_u32 s82, s82, s61
    v_lshl_add_u32 v6, v5, 2, s83
    v_bfrev_b32 v4, 64
    s_mov_b32 s49, 12845056
    s_waitcnt lgkmcnt(0)
    ds_read_b32 v47, v6 offset:1792
    ds_read_b32 v46, v6 offset:1536
    ds_read_b32 v40, v6 offset:0
    ds_read_b32 v41, v6 offset:256
    ds_read_b32 v42, v6 offset:512
    ds_read_b32 v43, v6 offset:768
    ds_read_b32 v44, v6 offset:1024
    ds_read_b32 v45, v6 offset:1280
    v_add_u32 v48, 0, v5
    v_cmp_gt_u32 s[20:21], s82, v48
    v_add_u32 v49, 64, v5
    v_cmp_gt_u32 s[22:23], s82, v49
    v_add_u32 v50, 128, v5
    v_cmp_gt_u32 s[24:25], s82, v50
    v_add_u32 v51, 192, v5
    v_cmp_gt_u32 s[26:27], s82, v51
    v_add_u32 v52, 256, v5
    v_cmp_gt_u32 s[28:29], s82, v52
    v_add_u32 v53, 320, v5
    v_cmp_gt_u32 s[30:31], s82, v53
    v_add_u32 v54, 384, v5
    v_cmp_gt_u32 s[32:33], s82, v54
    v_add_u32 v55, 448, v5
    v_cmp_gt_u32 s[34:35], s82, v55
    s_waitcnt lgkmcnt(7)
    v_add_u32 v47, v47, v55
    v_lshlrev_b32 v135, 4, v47
    v_and_b32 v55, -4, v47
    s_waitcnt lgkmcnt(6)
    v_add_u32 v46, v46, v54
    v_lshlrev_b32 v134, 4, v46
    v_and_b32 v54, -4, v46
    s_waitcnt lgkmcnt(5)
    v_add_u32 v40, v40, v48
    v_cndmask_b32 v40, v4, v40, s[20:21]
    v_lshlrev_b32 v128, 4, v40
    v_and_b32 v48, -4, v40
    s_waitcnt lgkmcnt(4)
    v_add_u32 v41, v41, v49
    v_cndmask_b32 v41, v4, v41, s[22:23]
    v_lshlrev_b32 v129, 4, v41
    v_and_b32 v49, -4, v41
    s_waitcnt lgkmcnt(3)
    v_add_u32 v42, v42, v50
    v_cndmask_b32 v42, v4, v42, s[24:25]
    v_lshlrev_b32 v130, 4, v42
    v_and_b32 v50, -4, v42
    s_waitcnt lgkmcnt(2)
    v_add_u32 v43, v43, v51
    v_cndmask_b32 v43, v4, v43, s[26:27]
    v_lshlrev_b32 v131, 4, v43
    v_and_b32 v51, -4, v43
    s_waitcnt lgkmcnt(1)
    v_add_u32 v44, v44, v52
    v_cndmask_b32 v44, v4, v44, s[28:29]
    v_lshlrev_b32 v132, 4, v44
    v_and_b32 v52, -4, v44
    s_waitcnt lgkmcnt(0)
    v_add_u32 v45, v45, v53
    v_cndmask_b32 v45, v4, v45, s[30:31]
    v_lshlrev_b32 v133, 4, v45
    v_and_b32 v53, -4, v45
    s_mov_b32 s48, 0
L_pf:
    s_waitcnt vmcnt(0)
    v_cmp_ne_u32 vcc, s78, v241
    s_add_u32 s48, s48, 1
    s_cmp_eq_u64 vcc, 0
    s_cbranch_scc1 L_pfd
    s_cmp_ge_u32 s48, 0x40000
    s_cbranch_scc1 L_pfd
    s_mov_b64 exec, vcc
    buffer_load_dword v241, v240, s[8:11], s70 offen sc1
    s_branch L_pf
L_pfd:
    s_mov_b64 exec, s[34:35]
    s_cbranch_execz L_no7
    buffer_load_dword v55, v55, s[8:11], s49 offen sc1
    buffer_load_dwordx4 v[100:103], v135, s[8:11], 0 offen sc1
L_no7:
    s_mov_b64 exec, s[32:33]
    s_cbranch_execz L_no6
    buffer_load_dword v54, v54, s[8:11], s49 offen sc1
    buffer_load_dwordx4 v[96:99], v134, s[8:11], 0 offen sc1
L_no6:
    s_mov_b64 exec, -1
    buffer_load_dword v48, v48, s[8:11], s49 offen sc1
    buffer_load_dword v49, v49, s[8:11], s49 offen sc1
    buffer_load_dword v50, v50, s[8:11], s49 offen sc1
    buffer_load_dword v51, v51, s[8:11], s49 offen sc1
    buffer_load_dword v52, v52, s[8:11], s49 offen sc1
    buffer_load_dword v53, v53, s[8:11], s49 offen sc1
    buffer_load_dwordx4 v[72:75], v128, s[8:11], 0 offen sc1
    buffer_load_dwordx4 v[76:79], v129, s[8:11], 0 offen sc1
    buffer_load_dwordx4 v[80:83], v130, s[8:11], 0 offen sc1
    buffer_load_dwordx4 v[84:87], v131, s[8:11], 0 offen sc1
    buffer_load_dwordx4 v[88:91], v132, s[8:11], 0 offen sc1
    buffer_load_dwordx4 v[92:95], v133, s[8:11], 0 offen sc1
    v_mov_b32 v4, 1
    v_lshlrev_b32 v40, 3, v40
    v_lshlrev_b32 v41, 3, v41
    v_lshlrev_b32 v42, 3, v42
    v_lshlrev_b32 v43, 3, v43
    v_lshlrev_b32 v44, 3, v44
    v_lshlrev_b32 v45, 3, v45
    v_lshlrev_b32 v46, 3, v46
    v_lshlrev_b32 v47, 3, v47
    s_waitcnt vmcnt(6)
    s_mov_b64 exec, s[20:21]
    s_cbranch_execz L_rk_done
    v_bfe_u32 v40, v48, v40, 8
    ds_add_rtn_u32 v48, v40, v4 offset:256
    s_mov_b64 exec, s[22:23]
    s_cbranch_execz L_rk_done
    v_bfe_u32 v41, v49, v41, 8
    ds_add_rtn_u32 v49, v41, v4 offset:256
    s_mov_b64 exec, s[24:25]
    s_cbranch_execz L_rk_done
    v_bfe_u32 v42, v50, v42, 8
    ds_add_rtn_u32 v50, v42, v4 offset:256
    s_mov_b64 exec, s[26:27]
    s_cbranch_execz L_rk_done
    v_bfe_u32 v43, v51, v43, 8
    ds_add_rtn_u32 v51, v43, v4 offset:256
    s_mov_b64 exec, s[28:29]
    s_cbranch_execz L_rk_done
    v_bfe_u32 v44, v52, v44, 8
    ds_add_rtn_u32 v52, v44, v4 offset:256
    s_mov_b64 exec, s[30:31]
    s_cbranch_execz L_rk_done
    v_bfe_u32 v45, v53, v45, 8
    ds_add_rtn_u32 v53, v45, v4 offset:256
    s_mov_b64 exec, s[32:33]
    s_cbranch_execz L_rk_done
    v_bfe_u32 v46, v54, v46, 8
    ds_add_rtn_u32 v54, v46, v4 offset:256
    s_mov_b64 exec, s[34:35]
    s_cbranch_execz L_rk_done
    v_bfe_u32 v47, v55, v47, 8
    ds_add_rtn_u32 v55, v47, v4 offset:256
L_rk_done:
    s_mov_b64 exec, -1
    s_cmp_eq_u32 s62, 0
    s_cbranch_scc1 L_nomore
    v_mov_b32 v6, 512
    ds_write_b32 v6, v4
L_nomore:
    v_lshlrev_b32 v6, 2, v5
    s_waitcnt lgkmcnt(0)
    s_barrier
    ds_read_b32 v104, v6 offset:256
    ds_read_b32 v106, v6 offset:512
    s_waitcnt lgkmcnt(0)
    v_mov_b32 v252, v104
    v_readfirstlane_b32 s62, v106
    s_nop 0
    v_add_u32_dpp v252, v252, v252 row_shr:1 row_mask:0xf bank_mask:0xf bound_ctrl:0
    s_nop 1
    v_add_u32_dpp v252, v252, v252 row_shr:2 row_mask:0xf bank_mask:0xf bound_ctrl:0
    s_nop 1
    v_add_u32_dpp v252, v252, v252 row_shr:4 row_mask:0xf bank_mask:0xf bound_ctrl:0
    s_nop 1
    v_add_u32_dpp v252, v252, v252 row_shr:8 row_mask:0xf bank_mask:0xf bound_ctrl:0
    s_nop 1
    v_add_u32_dpp v252, v252, v252 row_bcast:15 row_mask:0xa bank_mask:0xf
    s_nop 1
    v_add_u32_dpp v252, v252, v252 row_bcast:31 row_mask:0xc bank_mask:0xf
    v_sub_u32 v105, v252, v104
    v_readlane_b32 s82, v252, 63
    ds_bpermute_b32 v128, v40, v105
    ds_bpermute_b32 v129, v41, v105
    ds_bpermute_b32 v130, v42, v105
    ds_bpermute_b32 v131, v43, v105
    ds_bpermute_b32 v132, v44, v105
    ds_bpermute_b32 v133, v45, v105
    ds_bpermute_b32 v134, v46, v105
    ds_bpermute_b32 v135, v47, v105
    s_cmp_gt_u32 s82, 3456
    s_cselect_b32 s48, 1, s62
    s_cmp_eq_u32 s61, 512
    s_cselect_b32 s48, s48, 0
    s_cmp_lg_u32 s48, 0
    s_cbranch_scc1 L_restart
    s_cmp_eq_u32 s61, 512
    s_cbranch_scc1 L_nozacc
    s_cmp_lg_u32 s36, 0
    s_cbranch_scc1 L_nozacc
    v_mov_b32 v240, 0
    v_mov_b32 v241, 0
    v_mov_b32 v242, 0
    v_mov_b32 v243, 0
    v_lshlrev_b32 v6, 4, v5
    s_lshl_b32 s48, s79, 3
    s_add_u32 s48, s48, s77
    s_mul_i32 s48, s48, 36864
    s_add_u32 s49, s48, 36864
L_zacc:
    buffer_store_dwordx4 v[240:243], v6, s[96:99], s48 offen sc1
    s_add_u32 s48, s48, 1024
    s_cmp_lt_u32 s48, s49
    s_cbranch_scc1 L_zacc
    s_waitcnt vmcnt(0)
L_nozacc:
    s_waitcnt lgkmcnt(0)
    v_add_u32 v128, v128, v48
    v_lshlrev_b32 v48, 1, v128
    v_lshlrev_b32 v128, 4, v128
    v_add_u32 v129, v129, v49
    v_lshlrev_b32 v49, 1, v129
    v_lshlrev_b32 v129, 4, v129
    v_add_u32 v130, v130, v50
    v_lshlrev_b32 v50, 1, v130
    v_lshlrev_b32 v130, 4, v130
    v_add_u32 v131, v131, v51
    v_lshlrev_b32 v51, 1, v131
    v_lshlrev_b32 v131, 4, v131
    v_add_u32 v132, v132, v52
    v_lshlrev_b32 v52, 1, v132
    v_lshlrev_b32 v132, 4, v132
    v_add_u32 v133, v133, v53
    v_lshlrev_b32 v53, 1, v133
    v_lshlrev_b32 v133, 4, v133
    v_add_u32 v134, v134, v54
    v_lshlrev_b32 v54, 1, v134
    v_lshlrev_b32 v134, 4, v134
    v_add_u32 v135, v135, v55
    v_lshlrev_b32 v55, 1, v135
    v_lshlrev_b32 v135, 4, v135
    s_waitcnt vmcnt(6)
    s_mov_b64 exec, s[34:35]
    ds_write_b16_d16_hi v55, v103 offset:1024
    s_mov_b64 exec, s[32:33]
    ds_write_b16_d16_hi v54, v99 offset:1024
    s_mov_b64 exec, s[20:21]
    s_cbranch_execz L_s_done
    s_waitcnt vmcnt(5)
    ds_write_b16_d16_hi v48, v75 offset:1024
    s_mov_b64 exec, s[22:23]
    s_cbranch_execz L_s_done
    s_waitcnt vmcnt(4)
    ds_write_b16_d16_hi v49, v79 offset:1024
    s_mov_b64 exec, s[24:25]
    s_cbranch_execz L_s_done
    s_waitcnt vmcnt(3)
    ds_write_b16_d16_hi v50, v83 offset:1024
    s_mov_b64 exec, s[26:27]
    s_cbranch_execz L_s_done
    s_waitcnt vmcnt(2)
    ds_write_b16_d16_hi v51, v87 offset:1024
    s_mov_b64 exec, s[28:29]
    s_cbranch_execz L_s_done
    s_waitcnt vmcnt(1)
    ds_write_b16_d16_hi v52, v91 offset:1024
    s_mov_b64 exec, s[30:31]
    s_cbranch_execz L_s_done
    s_waitcnt vmcnt(0)
    ds_write_b16_d16_hi v53, v95 offset:1024
L_s_done:
    s_mov_b64 exec, -1
    s_add_u32 s48, s82, 31
    s_lshr_b32 s48, s48, 5
    s_and_b32 s49, s48, 7
    s_lshr_b32 s48, s48, 3
    s_mul_i32 s81, s48, s77
    s_min_u32 s38, s77, s49
    s_add_u32 s81, s81, s38
    s_cmp_lt_u32 s77, s49
    s_addc_u32 s38, s81, s48
    s_lshl_b32 s81, s81, 5
    s_lshl_b32 s38, s38, 5
    s_mov_b32 exec_hi, 0x1ffff
    v_cmp_gt_u32 vcc, s81, v105
    s_bcnt1_i32_b64 s39, vcc
    v_cmp_gt_u32 vcc, s38, v105
    s_bcnt1_i32_b64 s47, vcc
    s_mov_b64 exec, -1
    s_cmp_eq_u32 s77, 7
    s_cselect_b32 s47, 49, s47
    s_cselect_b32 s49, 1, 0
    s_sub_u32 s48, s47, s39
    s_max_u32 s48, s48, s49
    s_sub_u32 s48, s48, 1
    s_cmp_lg_u32 s61, 512
    s_cselect_b32 s48, 64, s48
    s_cmp_lt_u32 s48, 8
    s_cbranch_scc1 L_split_ok
    v_mov_b32 v4, 520
    ds_write_b32 v4, v4
L_split_ok:
    s_min_u32 s38, s38, s82
    s_and_b32 s37, s81, -32
    s_sub_u32 s55, s38, s37
    s_add_u32 s55, s55, 31
    s_lshr_b32 s55, s55, 5
    s_lshl_b32 s63, s37, 1
    s_add_u32 s63, s63, 1024
    v_bfe_u32 v4, v0, 4, 2
    v_lshl_add_u32 v251, v4, 4, s63
    s_sub_u32 s44, s55, 2
    v_mov_b32 v6, 0
    s_mov_b32 s45, 0
    s_mov_b32 s54, 0
    s_mov_b32 s76, 0
    s_mov_b32 s80, 0
    s_waitcnt lgkmcnt(0)
    s_barrier
    ds_read_b32 v6, v6 offset:520
    ds_read_b128 v[244:247], v251
    ds_read_b128 v[240:243], v251 offset:64
    s_waitcnt lgkmcnt(2)
    v_readfirstlane_b32 s48, v6
    s_cmp_eq_u32 s48, 0
    s_cbranch_scc1 L_even
    s_mul_i32 s39, s77, 7
    s_add_u32 s47, s39, 7
    s_min_u32 s47, s47, 49
    v_readlane_b32 s81, v105, s39
    v_readlane_b32 s38, v105, s47
    s_min_u32 s38, s38, s82
    s_and_b32 s37, s81, -32
    s_sub_u32 s55, s38, s37
    s_add_u32 s55, s55, 31
    s_lshr_b32 s55, s55, 5
    s_lshl_b32 s63, s37, 1
    s_add_u32 s63, s63, 1024
    v_bfe_u32 v4, v0, 4, 2
    v_lshl_add_u32 v251, v4, 4, s63
    s_sub_u32 s44, s55, 2
    s_waitcnt lgkmcnt(0)
    ds_read_b128 v[244:247], v251
    ds_read_b128 v[240:243], v251 offset:64
L_even:
    s_cmp_eq_u32 s55, 1
    s_cselect_b32 s83, 4, 8
    s_cmp_ge_u32 s81, s38
    s_cselect_b32 s83, 0, s83
    v_add_u32 v251, 128, v251
    s_waitcnt lgkmcnt(0)
    v_mad_u32_u16 v8, v244, s16, v248
    v_mad_u32_u16 v12, v244, s16, v248 op_sel:[1,0,0,0]
    v_mad_u32_u16 v16, v245, s16, v248
    v_mad_u32_u16 v20, v245, s16, v248 op_sel:[1,0,0,0]
    v_mad_u32_u16 v24, v246, s16, v248
    v_mad_u32_u16 v28, v246, s16, v248 op_sel:[1,0,0,0]
    v_mad_u32_u16 v32, v247, s16, v248
    v_mad_u32_u16 v36, v247, s16, v248 op_sel:[1,0,0,0]
    v_mad_u32_u16 v40, v240, s16, v248
    v_mad_u32_u16 v44, v240, s16, v248 op_sel:[1,0,0,0]
    v_mad_u32_u16 v48, v241, s16, v248
    v_mad_u32_u16 v52, v241, s16, v248 op_sel:[1,0,0,0]
    v_mad_u32_u16 v56, v242, s16, v248
    v_mad_u32_u16 v60, v242, s16, v248 op_sel:[1,0,0,0]
    v_mad_u32_u16 v64, v243, s16, v248
    v_mad_u32_u16 v68, v243, s16, v248 op_sel:[1,0,0,0]
    ds_read_b128 v[244:247], v251
    s_mov_b64 exec, -1
    s_cmp_le_u32 s83, 0
    s_cbranch_scc1 L_gp0
    buffer_load_dwordx4 v[8:11], v8, s[4:7], s45 offen
    buffer_load_dwordx4 v[12:15], v12, s[4:7], s45 offen
L_gp0:
    s_mov_b64 exec, -1
    s_cmp_le_u32 s83, 1
    s_cbranch_scc1 L_gp1
    buffer_load_dwordx4 v[16:19], v16, s[4:7], s45 offen
    buffer_load_dwordx4 v[20:23], v20, s[4:7], s45 offen
L_gp1:
    s_mov_b64 exec, s[20:21]
    s_cbranch_execz L_nou0
    v_lshlrev_b32 v108, 16, v72
    v_and_b32 v109, s19, v72
    v_lshlrev_b32 v110, 16, v73
    v_and_b32 v111, s19, v73
    v_lshlrev_b32 v112, 16, v74
    v_and_b32 v113, s19, v74
    v_lshlrev_b32 v114, 16, v75
    v_pk_mul_f32 v[116:117], v[108:109], v[112:113] op_sel_hi:[1,0]
    v_pk_mul_f32 v[118:119], v[110:111], v[112:113] op_sel_hi:[1,0]
    v_cvt_pk_bf16_f32 v74, v116, v117
    v_cvt_pk_bf16_f32 v75, v118, v119
    ds_write_b128 v128, v[72:75] offset:12032
    v_add_u32 v128, 67392, v128
    v_pk_mul_f32 v[116:117], v[108:109], v[112:113] op_sel:[0,1] op_sel_hi:[1,1]
    v_pk_mul_f32 v[118:119], v[110:111], v[112:113] op_sel:[0,1] op_sel_hi:[1,1]
    v_cvt_pk_bf16_f32 v120, v116, v117
    v_cvt_pk_bf16_f32 v121, v118, v119
    v_pk_mul_f32 v[116:117], v[108:109], v[114:115] op_sel_hi:[1,0]
    v_pk_mul_f32 v[118:119], v[110:111], v[114:115] op_sel_hi:[1,0]
    v_cvt_pk_bf16_f32 v122, v116, v117
    v_cvt_pk_bf16_f32 v123, v118, v119
    ds_write_b128 v128, v[120:123]
L_nou0:
    s_mov_b64 exec, -1
    s_cmp_le_u32 s83, 2
    s_cbranch_scc1 L_gp2
    buffer_load_dwordx4 v[24:27], v24, s[4:7], s45 offen
    buffer_load_dwordx4 v[28:31], v28, s[4:7], s45 offen
L_gp2:
    s_mov_b64 exec, s[22:23]
    s_cbranch_execz L_nou1
    v_lshlrev_b32 v108, 16, v76
    v_and_b32 v109, s19, v76
    v_lshlrev_b32 v110, 16, v77
    v_and_b32 v111, s19, v77
    v_lshlrev_b32 v112, 16, v78
    v_and_b32 v113, s19, v78
    v_lshlrev_b32 v114, 16, v79
    v_pk_mul_f32 v[116:117], v[108:109], v[112:113] op_sel_hi:[1,0]
    v_pk_mul_f32 v[118:119], v[110:111], v[112:113] op_sel_hi:[1,0]
    v_cvt_pk_bf16_f32 v78, v116, v117
    v_cvt_pk_bf16_f32 v79, v118, v119
    ds_write_b128 v129, v[76:79] offset:12032
    v_add_u32 v129, 67392, v129
    v_pk_mul_f32 v[116:117], v[108:109], v[112:113] op_sel:[0,1] op_sel_hi:[1,1]
    v_pk_mul_f32 v[118:119], v[110:111], v[112:113] op_sel:[0,1] op_sel_hi:[1,1]
    v_cvt_pk_bf16_f32 v124, v116, v117
    v_cvt_pk_bf16_f32 v125, v118, v119
    v_pk_mul_f32 v[116:117], v[108:109], v[114:115] op_sel_hi:[1,0]
    v_pk_mul_f32 v[118:119], v[110:111], v[114:115] op_sel_hi:[1,0]
    v_cvt_pk_bf16_f32 v126, v116, v117
    v_cvt_pk_bf16_f32 v127, v118, v119
    ds_write_b128 v129, v[124:127]
L_nou1:
    s_mov_b64 exec, -1
    s_cmp_le_u32 s83, 3
    s_cbranch_scc1 L_gp3
    buffer_load_dwordx4 v[32:35], v32, s[4:7], s45 offen
    buffer_load_dwordx4 v[36:39], v36, s[4:7], s45 offen
L_gp3:
    s_mov_b64 exec, s[24:25]
    s_cbranch_execz L_nou2
    v_lshlrev_b32 v108, 16, v80
    v_and_b32 v109, s19, v80
    v_lshlrev_b32 v110, 16, v81
    v_and_b32 v111, s19, v81
    v_lshlrev_b32 v112, 16, v82
    v_and_b32 v113, s19, v82
    v_lshlrev_b32 v114, 16, v83
    v_pk_mul_f32 v[116:117], v[108:109], v[112:113] op_sel_hi:[1,0]
    v_pk_mul_f32 v[118:119], v[110:111], v[112:113] op_sel_hi:[1,0]
    v_cvt_pk_bf16_f32 v82, v116, v117
    v_cvt_pk_bf16_f32 v83, v118, v119
    ds_write_b128 v130, v[80:83] offset:12032
    v_add_u32 v130, 67392, v130
    v_pk_mul_f32 v[116:117], v[108:109], v[112:113] op_sel:[0,1] op_sel_hi:[1,1]
    v_pk_mul_f32 v[118:119], v[110:111], v[112:113] op_sel:[0,1] op_sel_hi:[1,1]
    v_cvt_pk_bf16_f32 v120, v116, v117
    v_cvt_pk_bf16_f32 v121, v118, v119
    v_pk_mul_f32 v[116:117], v[108:109], v[114:115] op_sel_hi:[1,0]
    v_pk_mul_f32 v[118:119], v[110:111], v[114:115] op_sel_hi:[1,0]
    v_cvt_pk_bf16_f32 v122, v116, v117
    v_cvt_pk_bf16_f32 v123, v118, v119
    ds_write_b128 v130, v[120:123]
L_nou2:
    s_mov_b64 exec, -1
    s_cmp_le_u32 s83, 4
    s_cbranch_scc1 L_gp4
    buffer_load_dwordx4 v[40:43], v40, s[4:7], s45 offen
    buffer_load_dwordx4 v[44:47], v44, s[4:7], s45 offen
L_gp4:
    s_mov_b64 exec, s[26:27]
    s_cbranch_execz L_nou3
    v_lshlrev_b32 v108, 16, v84
    v_and_b32 v109, s19, v84
    v_lshlrev_b32 v110, 16, v85
    v_and_b32 v111, s19, v85
    v_lshlrev_b32 v112, 16, v86
    v_and_b32 v113, s19, v86
    v_lshlrev_b32 v114, 16, v87
    v_pk_mul_f32 v[116:117], v[108:109], v[112:113] op_sel_hi:[1,0]
    v_pk_mul_f32 v[118:119], v[110:111], v[112:113] op_sel_hi:[1,0]
    v_cvt_pk_bf16_f32 v86, v116, v117
    v_cvt_pk_bf16_f32 v87, v118, v119
    ds_write_b128 v131, v[84:87] offset:12032
    v_add_u32 v131, 67392, v131
    v_pk_mul_f32 v[116:117], v[108:109], v[112:113] op_sel:[0,1] op_sel_hi:[1,1]
    v_pk_mul_f32 v[118:119], v[110:111], v[112:113] op_sel:[0,1] op_sel_hi:[1,1]
    v_cvt_pk_bf16_f32 v124, v116, v117
    v_cvt_pk_bf16_f32 v125, v118, v119
    v_pk_mul_f32 v[116:117], v[108:109], v[114:115] op_sel_hi:[1,0]
    v_pk_mul_f32 v[118:119], v[110:111], v[114:115] op_sel_hi:[1,0]
    v_cvt_pk_bf16_f32 v126, v116, v117
    v_cvt_pk_bf16_f32 v127, v118, v119
    ds_write_b128 v131, v[124:127]
L_nou3:
    s_mov_b64 exec, -1
    s_cmp_le_u32 s83, 5
    s_cbranch_scc1 L_gp5
    buffer_load_dwordx4 v[48:51], v48, s[4:7], s45 offen
    buffer_load_dwordx4 v[52:55], v52, s[4:7], s45 offen
L_gp5:
    s_mov_b64 exec, s[28:29]
    s_cbranch_execz L_nou4
    v_lshlrev_b32 v108, 16, v88
    v_and_b32 v109, s19, v88
    v_lshlrev_b32 v110, 16, v89
    v_and_b32 v111, s19, v89
    v_lshlrev_b32 v112, 16, v90
    v_and_b32 v113, s19, v90
    v_lshlrev_b32 v114, 16, v91
    v_pk_mul_f32 v[116:117], v[108:109], v[112:113] op_sel_hi:[1,0]
    v_pk_mul_f32 v[118:119], v[110:111], v[112:113] op_sel_hi:[1,0]
    v_cvt_pk_bf16_f32 v90, v116, v117
    v_cvt_pk_bf16_f32 v91, v118, v119
    ds_write_b128 v132, v[88:91] offset:12032
    v_add_u32 v132, 67392, v132
    v_pk_mul_f32 v[116:117], v[108:109], v[112:113] op_sel:[0,1] op_sel_hi:[1,1]
    v_pk_mul_f32 v[118:119], v[110:111], v[112:113] op_sel:[0,1] op_sel_hi:[1,1]
    v_cvt_pk_bf16_f32 v120, v116, v117
    v_cvt_pk_bf16_f32 v121, v118, v119
    v_pk_mul_f32 v[116:117], v[108:109], v[114:115] op_sel_hi:[1,0]
    v_pk_mul_f32 v[118:119], v[110:111], v[114:115] op_sel_hi:[1,0]
    v_cvt_pk_bf16_f32 v122, v116, v117
    v_cvt_pk_bf16_f32 v123, v118, v119
    ds_write_b128 v132, v[120:123]
L_nou4:
    s_mov_b64 exec, -1
    s_cmp_le_u32 s83, 6
    s_cbranch_scc1 L_gp6
    buffer_load_dwordx4 v[56:59], v56, s[4:7], s45 offen
    buffer_load_dwordx4 v[60:63], v60, s[4:7], s45 offen
L_gp6:
    s_mov_b64 exec, s[30:31]
    s_cbranch_execz L_nou5
    v_lshlrev_b32 v108, 16, v92
    v_and_b32 v109, s19, v92
    v_lshlrev_b32 v110, 16, v93
    v_and_b32 v111, s19, v93
    v_lshlrev_b32 v112, 16, v94
    v_and_b32 v113, s19, v94
    v_lshlrev_b32 v114, 16, v95
    v_pk_mul_f32 v[116:117], v[108:109], v[112:113] op_sel_hi:[1,0]
    v_pk_mul_f32 v[118:119], v[110:111], v[112:113] op_sel_hi:[1,0]
    v_cvt_pk_bf16_f32 v94, v116, v117
    v_cvt_pk_bf16_f32 v95, v118, v119
    ds_write_b128 v133, v[92:95] offset:12032
    v_add_u32 v133, 67392, v133
    v_pk_mul_f32 v[116:117], v[108:109], v[112:113] op_sel:[0,1] op_sel_hi:[1,1]
    v_pk_mul_f32 v[118:119], v[110:111], v[112:113] op_sel:[0,1] op_sel_hi:[1,1]
    v_cvt_pk_bf16_f32 v124, v116, v117
    v_cvt_pk_bf16_f32 v125, v118, v119
    v_pk_mul_f32 v[116:117], v[108:109], v[114:115] op_sel_hi:[1,0]
    v_pk_mul_f32 v[118:119], v[110:111], v[114:115] op_sel_hi:[1,0]
    v_cvt_pk_bf16_f32 v126, v116, v117
    v_cvt_pk_bf16_f32 v127, v118, v119
    ds_write_b128 v133, v[124:127]
L_nou5:
    s_mov_b64 exec, -1
    s_cmp_le_u32 s83, 7
    s_cbranch_scc1 L_gp7
    buffer_load_dwordx4 v[64:67], v64, s[4:7], s45 offen
    buffer_load_dwordx4 v[68:71], v68, s[4:7], s45 offen
L_gp7:
    s_mov_b64 exec, s[32:33]
    s_cbranch_execz L_nou6
    v_lshlrev_b32 v108, 16, v96
    v_and_b32 v109, s19, v96
    v_lshlrev_b32 v110, 16, v97
    v_and_b32 v111, s19, v97
    v_lshlrev_b32 v112, 16, v98
    v_and_b32 v113, s19, v98
    v_lshlrev_b32 v114, 16, v99
    v_pk_mul_f32 v[116:117], v[108:109], v[112:113] op_sel_hi:[1,0]
    v_pk_mul_f32 v[118:119], v[110:111], v[112:113] op_sel_hi:[1,0]
    v_cvt_pk_bf16_f32 v98, v116, v117
    v_cvt_pk_bf16_f32 v99, v118, v119
    ds_write_b128 v134, v[96:99] offset:12032
    v_add_u32 v134, 67392, v134
    v_pk_mul_f32 v[116:117], v[108:109], v[112:113] op_sel:[0,1] op_sel_hi:[1,1]
    v_pk_mul_f32 v[118:119], v[110:111], v[112:113] op_sel:[0,1] op_sel_hi:[1,1]
    v_cvt_pk_bf16_f32 v120, v116, v117
    v_cvt_pk_bf16_f32 v121, v118, v119
    v_pk_mul_f32 v[116:117], v[108:109], v[114:115] op_sel_hi:[1,0]
    v_pk_mul_f32 v[118:119], v[110:111], v[114:115] op_sel_hi:[1,0]
    v_cvt_pk_bf16_f32 v122, v116, v117
    v_cvt_pk_bf16_f32 v123, v118, v119
    ds_write_b128 v134, v[120:123]
L_nou6:
    s_mov_b64 exec, s[34:35]
    s_cbranch_execz L_nou7
    v_lshlrev_b32 v108, 16, v100
    v_and_b32 v109, s19, v100
    v_lshlrev_b32 v110, 16, v101
    v_and_b32 v111, s19, v101
    v_lshlrev_b32 v112, 16, v102
    v_and_b32 v113, s19, v102
    v_lshlrev_b32 v114, 16, v103
    v_pk_mul_f32 v[116:117], v[108:109], v[112:113] op_sel_hi:[1,0]
    v_pk_mul_f32 v[118:119], v[110:111], v[112:113] op_sel_hi:[1,0]
    v_cvt_pk_bf16_f32 v102, v116, v117
    v_cvt_pk_bf16_f32 v103, v118, v119
    ds_write_b128 v135, v[100:103] offset:12032
    v_add_u32 v135, 67392, v135
    v_pk_mul_f32 v[116:117], v[108:109], v[112:113] op_sel:[0,1] op_sel_hi:[1,1]
    v_pk_mul_f32 v[118:119], v[110:111], v[112:113] op_sel:[0,1] op_sel_hi:[1,1]
    v_cvt_pk_bf16_f32 v124, v116, v117
    v_cvt_pk_bf16_f32 v125, v118, v119
    v_pk_mul_f32 v[116:117], v[108:109], v[114:115] op_sel_hi:[1,0]
    v_pk_mul_f32 v[118:119], v[110:111], v[114:115] op_sel_hi:[1,0]
    v_cvt_pk_bf16_f32 v126, v116, v117
    v_cvt_pk_bf16_f32 v127, v118, v119
    ds_write_b128 v135, v[124:127]
L_nou7:
L_u_done:
    s_mov_b64 exec, -1
    v_mov_b64 v[104:105], 0
    v_mov_b64 v[106:107], 0
    v_mov_b64 v[108:109], 0
    v_mov_b64 v[110:111], 0
    v_mov_b64 v[112:113], 0
    v_mov_b64 v[114:115], 0
    v_mov_b64 v[116:117], 0
    v_mov_b64 v[118:119], 0
    v_mov_b64 v[120:121], 0
    v_mov_b64 v[122:123], 0
    v_mov_b64 v[124:125], 0
    v_mov_b64 v[126:127], 0
    v_mov_b64 v[128:129], 0
    v_mov_b64 v[130:131], 0
    v_mov_b64 v[132:133], 0
    v_mov_b64 v[134:135], 0
    s_add_u32 s51, s37, 32
    s_mov_b32 s41, s81
    s_sub_u32 s40, s39, 1
    s_max_i32 s48, s40, 0
    v_readlane_b32 s42, v252, s48
    v_readlane_b32 s49, v252, s39
    s_lshl_b32 s48, s37, 4
    v_add_u32 v255, s48, v250
    s_cmp_eq_u32 s39, 0
    s_cselect_b32 s42, 0, s42
    s_cmp_gt_u32 s42, s81
    s_cselect_b32 s42, s42, s49
    s_cselect_b32 s40, s40, s39
    s_cselect_b32 s46, 0, 4
    s_cselect_b32 s76, 1, 0
    s_min_u32 s42, s42, s38
    s_mov_b32 s43, s42
    s_sub_u32 s48, s51, s41
    s_sub_u32 s49, s42, s41
    s_sub_u32 s48, s48, 32
    v_add_u32 v253, s48, v249
    v_add_u32 v254, 4, v253
    v_cmp_gt_u32 vcc, s49, v253
    v_cmp_gt_u32 s[52:53], s49, v254
    s_nop 0
    v_cndmask_b32 v253, 0, v255, vcc
    v_cndmask_b32 v254, 0, v255, s[52:53]
    s_mul_i32 s48, s55, 9
    s_lshr_b32 s48, s48, 4
    s_sub_u32 s58, s55, s48
    s_sub_u32 s58, s58, 2
    s_waitcnt lgkmcnt(0)
    s_barrier
    s_cmp_lt_u32 s81, s38
    s_cbranch_scc1 L_work
    s_mov_b32 s76, 0
    s_barrier
    s_branch L_loop_done
L_work:
    ds_read_b64_tr_b16 v[240:241], v253
    ds_read_b64_tr_b16 v[242:243], v254 offset:64
    s_setprio 2
    s_cmp_lt_u32 s77, 4
    s_cbranch_scc1 L_pr0
    s_setprio 1
    s_mov_b32 s58, 0x40000000
L_pr0:
    s_cmp_gt_u32 s55, 1
    s_cbranch_scc1 L_x
    v_mbcnt_lo_u32_b32 v253, -1, 0
    v_mbcnt_hi_u32_b32 v253, -1, v253
    v_and_b32 v253, 48, v253
    v_add_u32 v251, s63, v253
    s_waitcnt lgkmcnt(0)
    ds_read_b128 v[244:247], v251
    s_barrier
    s_mov_b32 s45, 256
    s_mov_b32 s80, 1
    s_waitcnt lgkmcnt(0)
    s_mov_b32 s44, 0
    v_mad_u32_u16 v40, v244, s16, v248
    v_mad_u32_u16 v44, v244, s16, v248 op_sel:[1,0,0,0]
    v_mad_u32_u16 v48, v245, s16, v248
    v_mad_u32_u16 v52, v245, s16, v248 op_sel:[1,0,0,0]
    v_mad_u32_u16 v56, v246, s16, v248
    v_mad_u32_u16 v60, v246, s16, v248 op_sel:[1,0,0,0]
    v_mad_u32_u16 v64, v247, s16, v248
    v_mad_u32_u16 v68, v247, s16, v248 op_sel:[1,0,0,0]
    buffer_load_dwordx4 v[40:43], v40, s[4:7], s45 offen
    buffer_load_dwordx4 v[44:47], v44, s[4:7], s45 offen
    buffer_load_dwordx4 v[48:51], v48, s[4:7], s45 offen
    buffer_load_dwordx4 v[52:55], v52, s[4:7], s45 offen
    buffer_load_dwordx4 v[56:59], v56, s[4:7], s45 offen
    buffer_load_dwordx4 v[60:63], v60, s[4:7], s45 offen
    buffer_load_dwordx4 v[64:67], v64, s[4:7], s45 offen
    buffer_load_dwordx4 v[68:71], v68, s[4:7], s45 offen
L_x:
    s_cmp_eq_u32 s44, 0
    s_cbranch_scc1 L_evx
    s_waitcnt vmcnt(8)
    v_perm_b32 v72, v12, v8, s17
    v_perm_b32 v76, v12, v8, s18
    v_perm_b32 v80, v13, v9, s17
    v_perm_b32 v84, v13, v9, s18
    v_perm_b32 v88, v14, v10, s17
    v_perm_b32 v92, v14, v10, s18
    v_perm_b32 v96, v15, v11, s17
    v_perm_b32 v100, v15, v11, s18
    s_waitcnt lgkmcnt(2)
    v_mad_u32_u16 v8, v244, s16, v248
    v_mad_u32_u16 v12, v244, s16, v248 op_sel:[1,0,0,0]
    v_perm_b32 v73, v20, v16, s17
    v_perm_b32 v77, v20, v16, s18
    v_perm_b32 v81, v21, v17, s17
    v_perm_b32 v85, v21, v17, s18
    v_perm_b32 v89, v22, v18, s17
    v_perm_b32 v93, v22, v18, s18
    v_perm_b32 v97, v23, v19, s17
    v_perm_b32 v101, v23, v19, s18
    v_mad_u32_u16 v16, v245, s16, v248
    v_mad_u32_u16 v20, v245, s16, v248 op_sel:[1,0,0,0]
    v_perm_b32 v74, v28, v24, s17
    v_perm_b32 v78, v28, v24, s18
    v_perm_b32 v82, v29, v25, s17
    v_perm_b32 v86, v29, v25, s18
    v_perm_b32 v90, v30, v26, s17
    v_perm_b32 v94, v30, v26, s18
    v_perm_b32 v98, v31, v27, s17
    v_perm_b32 v102, v31, v27, s18
    v_mad_u32_u16 v24, v246, s16, v248
    v_mad_u32_u16 v28, v246, s16, v248 op_sel:[1,0,0,0]
    v_perm_b32 v75, v36, v32, s17
    v_perm_b32 v79, v36, v32, s18
    v_perm_b32 v83, v37, v33, s17
    v_perm_b32 v87, v37, v33, s18
    v_perm_b32 v91, v38, v34, s17
    v_perm_b32 v95, v38, v34, s18
    v_perm_b32 v99, v39, v35, s17
    v_perm_b32 v103, v39, v35, s18
    v_mad_u32_u16 v32, v247, s16, v248
    v_mad_u32_u16 v36, v247, s16, v248 op_sel:[1,0,0,0]
    s_waitcnt lgkmcnt(0)
L_mx:
    v_mfma_f32_16x16x32_bf16 v[104:107], v[240:243], v[72:75], v[104:107]
    s_sub_u32 s44, s44, 1
    v_add_u32 v251, 64, v251
    ds_read_b128 v[244:247], v251
    v_mfma_f32_16x16x32_bf16 v[108:111], v[240:243], v[76:79], v[108:111]
    s_cmp_eq_u32 s44, s58
    s_cbranch_scc1 L_lpx
L_lpbx:
    s_cmp_gt_u32 s43, s51
    s_cbranch_scc1 L_nx
    v_mfma_f32_16x16x32_bf16 v[112:115], v[240:243], v[80:83], v[112:115]
    s_add_u32 s40, s40, 1
    s_mov_b32 s41, s42
    v_readlane_b32 s42, v252, s40
    v_mfma_f32_16x16x32_bf16 v[116:119], v[240:243], v[84:87], v[116:119]
    s_mov_b32 s50, s46
    s_add_u32 s46, s46, 4
    s_min_u32 s42, s42, s38
    v_mfma_f32_16x16x32_bf16 v[120:123], v[240:243], v[88:91], v[120:123]
    s_cmp_ge_u32 s40, s47
    s_cselect_b32 s43, -1, s42
    s_sub_u32 s48, s51, s41
    v_mfma_f32_16x16x32_bf16 v[124:127], v[240:243], v[92:95], v[124:127]
    s_sub_u32 s49, s42, s41
    s_sub_u32 s48, s48, 32
    v_add_u32 v253, s48, v249
    v_mfma_f32_16x16x32_bf16 v[128:131], v[240:243], v[96:99], v[128:131]
    v_add_u32 v254, 4, v253
    v_cmp_gt_u32 vcc, s49, v253
    v_cmp_gt_u32 s[52:53], s49, v254
    v_mfma_f32_16x16x32_bf16 v[132:135], v[240:243], v[100:103], v[132:135]
    s_nop 0
    v_cndmask_b32 v253, 0, v255, vcc
    v_cndmask_b32 v254, 0, v255, s[52:53]
L_fx:
    ds_read_b64_tr_b16 v[0:1], v253
    ds_read_b64_tr_b16 v[2:3], v254 offset:64
    s_cmp_lg_u32 s61, 512
    s_cbranch_scc1 L_accx
    v_pk_mul_f32 v[104:105], v[104:105], v[136:137]
    v_pk_mul_f32 v[108:109], v[108:109], v[140:141]
    v_pk_mul_f32 v[112:113], v[112:113], v[144:145]
    v_pk_mul_f32 v[116:117], v[116:117], v[148:149]
    v_pk_fma_f32 v[104:105], v[106:107], v[138:139], v[104:105]
    v_pk_fma_f32 v[108:109], v[110:111], v[142:143], v[108:109]
    v_pk_fma_f32 v[112:113], v[114:115], v[146:147], v[112:113]
    v_pk_fma_f32 v[116:117], v[118:119], v[150:151], v[116:117]
    v_add_f32 v104, v104, v105
    v_add_f32 v108, v108, v109
    v_add_f32 v112, v112, v113
    v_add_f32 v116, v116, v117
    v_pk_mul_f32 v[120:121], v[120:121], v[152:153]
    v_pk_mul_f32 v[124:125], v[124:125], v[156:157]
    v_cvt_pk_bf16_f32 v4, v104, v108
    v_cvt_pk_bf16_f32 v5, v112, v116
    s_waitcnt lgkmcnt(0)
    v_mfma_f32_16x16x32_bf16 v[104:107], v[0:3], v[72:75], 0
    v_pk_fma_f32 v[120:121], v[122:123], v[154:155], v[120:121]
    v_pk_fma_f32 v[124:125], v[126:127], v[158:159], v[124:125]
    v_mfma_f32_16x16x32_bf16 v[108:111], v[0:3], v[76:79], 0
    v_add_f32 v120, v120, v121
    v_add_f32 v124, v124, v125
    v_mfma_f32_16x16x32_bf16 v[112:115], v[0:3], v[80:83], 0
    v_pk_mul_f32 v[128:129], v[128:129], v[160:161]
    v_cvt_pk_bf16_f32 v6, v120, v124
    v_mfma_f32_16x16x32_bf16 v[116:119], v[0:3], v[84:87], 0
    v_pk_mul_f32 v[132:133], v[132:133], v[164:165]
    v_pk_fma_f32 v[128:129], v[130:131], v[162:163], v[128:129]
    v_mfma_f32_16x16x32_bf16 v[120:123], v[0:3], v[88:91], 0
    v_pk_fma_f32 v[132:133], v[134:135], v[166:167], v[132:133]
    v_add_f32 v128, v128, v129
    v_mfma_f32_16x16x32_bf16 v[124:127], v[0:3], v[92:95], 0
    v_add_f32 v132, v132, v133
    v_cvt_pk_bf16_f32 v7, v128, v132
L_packx:
    v_mfma_f32_16x16x32_bf16 v[128:131], v[0:3], v[96:99], 0
    s_set_gpr_idx_on s50, gpr_idx(DST)
    v_mov_b32 v168, v4
    v_mov_b32 v169, v5
    v_mov_b32 v170, v6
    v_mov_b32 v171, v7
    s_set_gpr_idx_off
    v_mfma_f32_16x16x32_bf16 v[132:135], v[0:3], v[100:103], 0
    s_cmp_le_u32 s43, s51
    s_cbranch_scc1 L_againx
    s_cmp_ge_u32 s51, s38
    s_cbranch_scc1 L_phx
    s_sub_u32 s48, s42, s51
    s_add_u32 s51, s51, 32
    s_sub_u32 s49, s48, 4
    v_cmp_gt_i32 vcc, s48, v249
    v_cmp_gt_i32 s[52:53], s49, v249
    v_add_u32 v255, 512, v255
    v_cndmask_b32 v253, 0, v255, vcc
    v_cndmask_b32 v254, 0, v255, s[52:53]
    ds_read_b64_tr_b16 v[240:241], v253
    ds_read_b64_tr_b16 v[242:243], v254 offset:64
    s_cmp_eq_u32 s80, 2
    s_cbranch_scc1 L_y
    buffer_load_dwordx4 v[8:11], v8, s[4:7], s45 offen
    buffer_load_dwordx4 v[12:15], v12, s[4:7], s45 offen
    buffer_load_dwordx4 v[16:19], v16, s[4:7], s45 offen
    buffer_load_dwordx4 v[20:23], v20, s[4:7], s45 offen
    buffer_load_dwordx4 v[24:27], v24, s[4:7], s45 offen
    buffer_load_dwordx4 v[28:31], v28, s[4:7], s45 offen
    buffer_load_dwordx4 v[32:35], v32, s[4:7], s45 offen
    buffer_load_dwordx4 v[36:39], v36, s[4:7], s45 offen
    s_branch L_y
L_nx:
    v_mfma_f32_16x16x32_bf16 v[112:115], v[240:243], v[80:83], v[112:115]
    s_sub_u32 s48, s42, s51
    s_add_u32 s51, s51, 32
    v_mfma_f32_16x16x32_bf16 v[116:119], v[240:243], v[84:87], v[116:119]
    s_sub_u32 s49, s48, 4
    v_mfma_f32_16x16x32_bf16 v[120:123], v[240:243], v[88:91], v[120:123]
    v_cmp_gt_i32 vcc, s48, v249
    v_mfma_f32_16x16x32_bf16 v[124:127], v[240:243], v[92:95], v[124:127]
    v_cmp_gt_i32 s[52:53], s49, v249
    v_add_u32 v255, 512, v255
    v_mfma_f32_16x16x32_bf16 v[128:131], v[240:243], v[96:99], v[128:131]
    v_cndmask_b32 v253, 0, v255, vcc
    v_mfma_f32_16x16x32_bf16 v[132:135], v[240:243], v[100:103], v[132:135]
    v_cndmask_b32 v254, 0, v255, s[52:53]
    ds_read_b64_tr_b16 v[240:241], v253
    ds_read_b64_tr_b16 v[242:243], v254 offset:64
    s_cmp_eq_u32 s80, 2
    s_cbranch_scc1 L_y
    buffer_load_dwordx4 v[8:11], v8, s[4:7], s45 offen
    buffer_load_dwordx4 v[12:15], v12, s[4:7], s45 offen
    buffer_load_dwordx4 v[16:19], v16, s[4:7], s45 offen
    buffer_load_dwordx4 v[20:23], v20, s[4:7], s45 offen
    buffer_load_dwordx4 v[24:27], v24, s[4:7], s45 offen
    buffer_load_dwordx4 v[28:31], v28, s[4:7], s45 offen
    buffer_load_dwordx4 v[32:35], v32, s[4:7], s45 offen
    buffer_load_dwordx4 v[36:39], v36, s[4:7], s45 offen
L_y:
    s_cmp_eq_u32 s44, 0
    s_cbranch_scc1 L_evy
    s_waitcnt vmcnt(8)
    v_perm_b32 v72, v44, v40, s17
    v_perm_b32 v76, v44, v40, s18
    v_perm_b32 v80, v45, v41, s17
    v_perm_b32 v84, v45, v41, s18
    v_perm_b32 v88, v46, v42, s17
    v_perm_b32 v92, v46, v42, s18
    v_perm_b32 v96, v47, v43, s17
    v_perm_b32 v100, v47, v43, s18
    s_waitcnt lgkmcnt(2)
    v_mad_u32_u16 v40, v244, s16, v248
    v_mad_u32_u16 v44, v244, s16, v248 op_sel:[1,0,0,0]
    v_perm_b32 v73, v52, v48, s17
    v_perm_b32 v77, v52, v48, s18
    v_perm_b32 v81, v53, v49, s17
    v_perm_b32 v85, v53, v49, s18
    v_perm_b32 v89, v54, v50, s17
    v_perm_b32 v93, v54, v50, s18
    v_perm_b32 v97, v55, v51, s17
    v_perm_b32 v101, v55, v51, s18
    v_mad_u32_u16 v48, v245, s16, v248
    v_mad_u32_u16 v52, v245, s16, v248 op_sel:[1,0,0,0]
    v_perm_b32 v74, v60, v56, s17
    v_perm_b32 v78, v60, v56, s18
    v_perm_b32 v82, v61, v57, s17
    v_perm_b32 v86, v61, v57, s18
    v_perm_b32 v90, v62, v58, s17
    v_perm_b32 v94, v62, v58, s18
    v_perm_b32 v98, v63, v59, s17
    v_perm_b32 v102, v63, v59, s18
    v_mad_u32_u16 v56, v246, s16, v248
    v_mad_u32_u16 v60, v246, s16, v248 op_sel:[1,0,0,0]
    v_perm_b32 v75, v68, v64, s17
    v_perm_b32 v79, v68, v64, s18
    v_perm_b32 v83, v69, v65, s17
    v_perm_b32 v87, v69, v65, s18
    v_perm_b32 v91, v70, v66, s17
    v_perm_b32 v95, v70, v66, s18
    v_perm_b32 v99, v71, v67, s17
    v_perm_b32 v103, v71, v67, s18
    v_mad_u32_u16 v64, v247, s16, v248
    v_mad_u32_u16 v68, v247, s16, v248 op_sel:[1,0,0,0]
    s_waitcnt lgkmcnt(0)
L_my:
    v_mfma_f32_16x16x32_bf16 v[104:107], v[240:243], v[72:75], v[104:107]
    s_sub_u32 s44, s44, 1
    v_add_u32 v251, 64, v251
    ds_read_b128 v[244:247], v251
    v_mfma_f32_16x16x32_bf16 v[108:111], v[240:243], v[76:79], v[108:111]
    s_cmp_eq_u32 s44, s58
    s_cbranch_scc1 L_lpy
L_lpby:
    s_cmp_gt_u32 s43, s51
    s_cbranch_scc1 L_ny
    v_mfma_f32_16x16x32_bf16 v[112:115], v[240:243], v[80:83], v[112:115]
    s_add_u32 s40, s40, 1
    s_mov_b32 s41, s42
    v_readlane_b32 s42, v252, s40
    v_mfma_f32_16x16x32_bf16 v[116:119], v[240:243], v[84:87], v[116:119]
    s_mov_b32 s50, s46
    s_add_u32 s46, s46, 4
    s_min_u32 s42, s42, s38
    v_mfma_f32_16x16x32_bf16 v[120:123], v[240:243], v[88:91], v[120:123]
    s_cmp_ge_u32 s40, s47
    s_cselect_b32 s43, -1, s42
    s_sub_u32 s48, s51, s41
    v_mfma_f32_16x16x32_bf16 v[124:127], v[240:243], v[92:95], v[124:127]
    s_sub_u32 s49, s42, s41
    s_sub_u32 s48, s48, 32
    v_add_u32 v253, s48, v249
    v_mfma_f32_16x16x32_bf16 v[128:131], v[240:243], v[96:99], v[128:131]
    v_add_u32 v254, 4, v253
    v_cmp_gt_u32 vcc, s49, v253
    v_cmp_gt_u32 s[52:53], s49, v254
    v_mfma_f32_16x16x32_bf16 v[132:135], v[240:243], v[100:103], v[132:135]
    s_nop 0
    v_cndmask_b32 v253, 0, v255, vcc
    v_cndmask_b32 v254, 0, v255, s[52:53]
L_fy:
    ds_read_b64_tr_b16 v[0:1], v253
    ds_read_b64_tr_b16 v[2:3], v254 offset:64
    s_cmp_lg_u32 s61, 512
    s_cbranch_scc1 L_accy
    v_pk_mul_f32 v[104:105], v[104:105], v[136:137]
    v_pk_mul_f32 v[108:109], v[108:109], v[140:141]
    v_pk_mul_f32 v[112:113], v[112:113], v[144:145]
    v_pk_mul_f32 v[116:117], v[116:117], v[148:149]
    v_pk_fma_f32 v[104:105], v[106:107], v[138:139], v[104:105]
    v_pk_fma_f32 v[108:109], v[110:111], v[142:143], v[108:109]
    v_pk_fma_f32 v[112:113], v[114:115], v[146:147], v[112:113]
    v_pk_fma_f32 v[116:117], v[118:119], v[150:151], v[116:117]
    v_add_f32 v104, v104, v105
    v_add_f32 v108, v108, v109
    v_add_f32 v112, v112, v113
    v_add_f32 v116, v116, v117
    v_pk_mul_f32 v[120:121], v[120:121], v[152:153]
    v_pk_mul_f32 v[124:125], v[124:125], v[156:157]
    v_cvt_pk_bf16_f32 v4, v104, v108
    v_cvt_pk_bf16_f32 v5, v112, v116
    s_waitcnt lgkmcnt(0)
    v_mfma_f32_16x16x32_bf16 v[104:107], v[0:3], v[72:75], 0
    v_pk_fma_f32 v[120:121], v[122:123], v[154:155], v[120:121]
    v_pk_fma_f32 v[124:125], v[126:127], v[158:159], v[124:125]
    v_mfma_f32_16x16x32_bf16 v[108:111], v[0:3], v[76:79], 0
    v_add_f32 v120, v120, v121
    v_add_f32 v124, v124, v125
    v_mfma_f32_16x16x32_bf16 v[112:115], v[0:3], v[80:83], 0
    v_pk_mul_f32 v[128:129], v[128:129], v[160:161]
    v_cvt_pk_bf16_f32 v6, v120, v124
    v_mfma_f32_16x16x32_bf16 v[116:119], v[0:3], v[84:87], 0
    v_pk_mul_f32 v[132:133], v[132:133], v[164:165]
    v_pk_fma_f32 v[128:129], v[130:131], v[162:163], v[128:129]
    v_mfma_f32_16x16x32_bf16 v[120:123], v[0:3], v[88:91], 0
    v_pk_fma_f32 v[132:133], v[134:135], v[166:167], v[132:133]
    v_add_f32 v128, v128, v129
    v_mfma_f32_16x16x32_bf16 v[124:127], v[0:3], v[92:95], 0
    v_add_f32 v132, v132, v133
    v_cvt_pk_bf16_f32 v7, v128, v132
L_packy:
    v_mfma_f32_16x16x32_bf16 v[128:131], v[0:3], v[96:99], 0
    s_set_gpr_idx_on s50, gpr_idx(DST)
    v_mov_b32 v168, v4
    v_mov_b32 v169, v5
    v_mov_b32 v170, v6
    v_mov_b32 v171, v7
    s_set_gpr_idx_off
    v_mfma_f32_16x16x32_bf16 v[132:135], v[0:3], v[100:103], 0
    s_cmp_le_u32 s43, s51
    s_cbranch_scc1 L_againy
    s_cmp_ge_u32 s51, s38
    s_cbranch_scc1 L_phy
    s_sub_u32 s48, s42, s51
    s_add_u32 s51, s51, 32
    s_sub_u32 s49, s48, 4
    v_cmp_gt_i32 vcc, s48, v249
    v_cmp_gt_i32 s[52:53], s49, v249
    v_add_u32 v255, 512, v255
    v_cndmask_b32 v253, 0, v255, vcc
    v_cndmask_b32 v254, 0, v255, s[52:53]
    ds_read_b64_tr_b16 v[240:241], v253
    ds_read_b64_tr_b16 v[242:243], v254 offset:64
    s_cmp_eq_u32 s80, 2
    s_cbranch_scc1 L_x
    buffer_load_dwordx4 v[40:43], v40, s[4:7], s45 offen
    buffer_load_dwordx4 v[44:47], v44, s[4:7], s45 offen
    buffer_load_dwordx4 v[48:51], v48, s[4:7], s45 offen
    buffer_load_dwordx4 v[52:55], v52, s[4:7], s45 offen
    buffer_load_dwordx4 v[56:59], v56, s[4:7], s45 offen
    buffer_load_dwordx4 v[60:63], v60, s[4:7], s45 offen
    buffer_load_dwordx4 v[64:67], v64, s[4:7], s45 offen
    buffer_load_dwordx4 v[68:71], v68, s[4:7], s45 offen
    s_branch L_x
L_ny:
    v_mfma_f32_16x16x32_bf16 v[112:115], v[240:243], v[80:83], v[112:115]
    s_sub_u32 s48, s42, s51
    s_add_u32 s51, s51, 32
    v_mfma_f32_16x16x32_bf16 v[116:119], v[240:243], v[84:87], v[116:119]
    s_sub_u32 s49, s48, 4
    v_mfma_f32_16x16x32_bf16 v[120:123], v[240:243], v[88:91], v[120:123]
    v_cmp_gt_i32 vcc, s48, v249
    v_mfma_f32_16x16x32_bf16 v[124:127], v[240:243], v[92:95], v[124:127]
    v_cmp_gt_i32 s[52:53], s49, v249
    v_add_u32 v255, 512, v255
    v_mfma_f32_16x16x32_bf16 v[128:131], v[240:243], v[96:99], v[128:131]
    v_cndmask_b32 v253, 0, v255, vcc
    v_mfma_f32_16x16x32_bf16 v[132:135], v[240:243], v[100:103], v[132:135]
    v_cndmask_b32 v254, 0, v255, s[52:53]
    ds_read_b64_tr_b16 v[240:241], v253
    ds_read_b64_tr_b16 v[242:243], v254 offset:64
    s_cmp_eq_u32 s80, 2
    s_cbranch_scc1 L_x
    buffer_load_dwordx4 v[40:43], v40, s[4:7], s45 offen
    buffer_load_dwordx4 v[44:47], v44, s[4:7], s45 offen
    buffer_load_dwordx4 v[48:51], v48, s[4:7], s45 offen
    buffer_load_dwordx4 v[52:55], v52, s[4:7], s45 offen
    buffer_load_dwordx4 v[56:59], v56, s[4:7], s45 offen
    buffer_load_dwordx4 v[60:63], v60, s[4:7], s45 offen
    buffer_load_dwordx4 v[64:67], v64, s[4:7], s45 offen
    buffer_load_dwordx4 v[68:71], v68, s[4:7], s45 offen
    s_branch L_x
L_evx:
    s_cmp_lg_u32 s80, 0
    s_cbranch_scc1 L_ev1x
    v_mbcnt_lo_u32_b32 v253, -1, 0
    v_mbcnt_hi_u32_b32 v253, -1, v253
    v_and_b32 v253, 48, v253
    v_add_u32 v251, s63, v253
    s_waitcnt lgkmcnt(0)
    ds_read_b128 v[244:247], v251
    s_barrier
    s_mov_b32 s45, 256
    s_mov_b32 s80, 1
    s_waitcnt lgkmcnt(0)
    s_mov_b32 s44, s55
    s_cmp_ge_u32 s77, 4
    s_cbranch_scc1 L_x
    s_setprio 2
    s_mul_i32 s48, s55, 12
    s_lshr_b32 s48, s48, 4
    s_sub_u32 s58, s55, s48
    s_branch L_x
L_ev1x:
    s_waitcnt vmcnt(8)
    s_cmp_eq_u32 s80, 1
    s_cbranch_scc1 L_ev2x
    s_waitcnt vmcnt(0)
L_ev2x:
    s_mov_b32 s80, 2
    s_mov_b32 s44, 1
    v_perm_b32 v72, v12, v8, s17
    v_perm_b32 v76, v12, v8, s18
    v_perm_b32 v80, v13, v9, s17
    v_perm_b32 v84, v13, v9, s18
    v_perm_b32 v88, v14, v10, s17
    v_perm_b32 v92, v14, v10, s18
    v_perm_b32 v96, v15, v11, s17
    v_perm_b32 v100, v15, v11, s18
    v_perm_b32 v73, v20, v16, s17
    v_perm_b32 v77, v20, v16, s18
    v_perm_b32 v81, v21, v17, s17
    v_perm_b32 v85, v21, v17, s18
    v_perm_b32 v89, v22, v18, s17
    v_perm_b32 v93, v22, v18, s18
    v_perm_b32 v97, v23, v19, s17
    v_perm_b32 v101, v23, v19, s18
    v_perm_b32 v74, v28, v24, s17
    v_perm_b32 v78, v28, v24, s18
    v_perm_b32 v82, v29, v25, s17
    v_perm_b32 v86, v29, v25, s18
    v_perm_b32 v90, v30, v26, s17
    v_perm_b32 v94, v30, v26, s18
    v_perm_b32 v98, v31, v27, s17
    v_perm_b32 v102, v31, v27, s18
    v_perm_b32 v75, v36, v32, s17
    v_perm_b32 v79, v36, v32, s18
    v_perm_b32 v83, v37, v33, s17
    v_perm_b32 v87, v37, v33, s18
    v_perm_b32 v91, v38, v34, s17
    v_perm_b32 v95, v38, v34, s18
    v_perm_b32 v99, v39, v35, s17
    v_perm_b32 v103, v39, v35, s18
    s_waitcnt lgkmcnt(0)
    s_branch L_mx
L_lpx:
    s_setprio 0
    s_branch L_lpbx
L_againx:
    s_add_u32 s40, s40, 1
    s_mov_b32 s41, s42
    v_readlane_b32 s42, v252, s40
    s_mov_b32 s50, s46
    s_add_u32 s46, s46, 4
    s_min_u32 s42, s42, s38
    s_cmp_ge_u32 s40, s47
    s_cselect_b32 s43, -1, s42
    s_sub_u32 s48, s51, s41
    s_sub_u32 s49, s42, s41
    s_sub_u32 s48, s48, 32
    v_add_u32 v253, s48, v249
    v_add_u32 v254, 4, v253
    v_cmp_gt_u32 vcc, s49, v253
    v_cmp_gt_u32 s[52:53], s49, v254
    s_nop 0
    v_cndmask_b32 v253, 0, v255, vcc
    v_cndmask_b32 v254, 0, v255, s[52:53]
    s_branch L_fx
L_phx:
    s_cmp_eq_u32 s54, 1
    s_cbranch_scc1 L_loop_end
    s_mov_b32 s54, 1
    v_mbcnt_lo_u32_b32 v253, -1, 0
    v_mbcnt_hi_u32_b32 v253, -1, v253
    v_lshlrev_b32 v253, 4, v253
    ds_read_b128 v[72:75], v253 offset:7936
    ds_read_b128 v[76:79], v253 offset:8960
    ds_read_b128 v[80:83], v253 offset:9984
    ds_read_b128 v[84:87], v253 offset:11008
    s_add_u32 s51, s37, 32
    s_mov_b32 s41, s81
    s_sub_u32 s40, s39, 1
    s_max_i32 s48, s40, 0
    v_readlane_b32 s42, v252, s48
    v_readlane_b32 s49, v252, s39
    s_lshl_b32 s48, s37, 4
    v_add_u32 v255, s48, v250
    s_cmp_eq_u32 s39, 0
    s_cselect_b32 s42, 0, s42
    s_cmp_gt_u32 s42, s81
    s_cselect_b32 s42, s42, s49
    s_cselect_b32 s40, s40, s39
    s_cselect_b32 s46, 36, 40
    s_cselect_b32 s76, 1, 0
    s_min_u32 s42, s42, s38
    s_mov_b32 s43, s42
    s_sub_u32 s48, s51, s41
    s_sub_u32 s49, s42, s41
    s_sub_u32 s48, s48, 32
    v_add_u32 v253, s48, v249
    v_add_u32 v254, 4, v253
    v_cmp_gt_u32 vcc, s49, v253
    v_cmp_gt_u32 s[52:53], s49, v254
    s_nop 0
    v_cndmask_b32 v253, 0, v255, vcc
    v_cndmask_b32 v254, 0, v255, s[52:53]
    ds_read_b64_tr_b16 v[240:241], v253
    ds_read_b64_tr_b16 v[242:243], v254 offset:64
    s_waitcnt lgkmcnt(2)
    v_lshlrev_b32 v136, 16, v72
    v_and_b32 v140, s19, v72
    v_lshlrev_b32 v144, 16, v73
    v_and_b32 v148, s19, v73
    v_lshlrev_b32 v152, 16, v74
    v_and_b32 v156, s19, v74
    v_lshlrev_b32 v160, 16, v75
    v_and_b32 v164, s19, v75
    v_lshlrev_b32 v137, 16, v76
    v_and_b32 v141, s19, v76
    v_lshlrev_b32 v145, 16, v77
    v_and_b32 v149, s19, v77
    v_lshlrev_b32 v153, 16, v78
    v_and_b32 v157, s19, v78
    v_lshlrev_b32 v161, 16, v79
    v_and_b32 v165, s19, v79
    v_lshlrev_b32 v138, 16, v80
    v_and_b32 v142, s19, v80
    v_lshlrev_b32 v146, 16, v81
    v_and_b32 v150, s19, v81
    v_lshlrev_b32 v154, 16, v82
    v_and_b32 v158, s19, v82
    v_lshlrev_b32 v162, 16, v83
    v_and_b32 v166, s19, v83
    v_lshlrev_b32 v139, 16, v84
    v_and_b32 v143, s19, v84
    v_lshlrev_b32 v147, 16, v85
    v_and_b32 v151, s19, v85
    v_lshlrev_b32 v155, 16, v86
    v_and_b32 v159, s19, v86
    v_lshlrev_b32 v163, 16, v87
    v_and_b32 v167, s19, v87
    s_cmp_eq_u32 s80, 2
    s_cbranch_scc1 L_y
    buffer_load_dwordx4 v[8:11], v8, s[4:7], s45 offen
    buffer_load_dwordx4 v[12:15], v12, s[4:7], s45 offen
    buffer_load_dwordx4 v[16:19], v16, s[4:7], s45 offen
    buffer_load_dwordx4 v[20:23], v20, s[4:7], s45 offen
    buffer_load_dwordx4 v[24:27], v24, s[4:7], s45 offen
    buffer_load_dwordx4 v[28:31], v28, s[4:7], s45 offen
    buffer_load_dwordx4 v[32:35], v32, s[4:7], s45 offen
    buffer_load_dwordx4 v[36:39], v36, s[4:7], s45 offen
    s_branch L_y
L_accx:
    v_mbcnt_lo_u32_b32 v253, -1, 0
    v_mbcnt_hi_u32_b32 v253, -1, v253
    v_lshlrev_b32 v253, 5, v253
    s_lshl_b32 s48, s79, 3
    s_add_u32 s48, s48, s77
    s_mul_i32 s48, s48, 36864
    s_lshl_b32 s49, s50, 9
    s_add_u32 s48, s48, s49
    s_waitcnt lgkmcnt(0)
    buffer_load_dwordx4 v[244:247], v253, s[96:99], s48 offen sc1
    buffer_load_dwordx4 v[4:7], v253, s[96:99], s48 offen offset:16 sc1
    v_pk_mul_f32 v[104:105], v[104:105], v[136:137]
    v_pk_mul_f32 v[108:109], v[108:109], v[140:141]
    v_pk_mul_f32 v[112:113], v[112:113], v[144:145]
    v_pk_mul_f32 v[116:117], v[116:117], v[148:149]
    v_pk_mul_f32 v[120:121], v[120:121], v[152:153]
    v_pk_mul_f32 v[124:125], v[124:125], v[156:157]
    v_pk_mul_f32 v[128:129], v[128:129], v[160:161]
    v_pk_mul_f32 v[132:133], v[132:133], v[164:165]
    v_pk_fma_f32 v[104:105], v[106:107], v[138:139], v[104:105]
    v_pk_fma_f32 v[108:109], v[110:111], v[142:143], v[108:109]
    v_pk_fma_f32 v[112:113], v[114:115], v[146:147], v[112:113]
    v_pk_fma_f32 v[116:117], v[118:119], v[150:151], v[116:117]
    v_pk_fma_f32 v[120:121], v[122:123], v[154:155], v[120:121]
    v_pk_fma_f32 v[124:125], v[126:127], v[158:159], v[124:125]
    v_pk_fma_f32 v[128:129], v[130:131], v[162:163], v[128:129]
    v_pk_fma_f32 v[132:133], v[134:135], v[166:167], v[132:133]
    v_add_f32 v104, v104, v105
    v_add_f32 v108, v108, v109
    v_add_f32 v112, v112, v113
    v_add_f32 v116, v116, v117
    v_add_f32 v120, v120, v121
    v_add_f32 v124, v124, v125
    v_add_f32 v128, v128, v129
    v_add_f32 v132, v132, v133
    s_waitcnt vmcnt(0)
    v_add_f32 v244, v244, v104
    v_mov_b32 v104, v244
    v_add_f32 v245, v245, v108
    v_mov_b32 v108, v245
    v_add_f32 v246, v246, v112
    v_mov_b32 v112, v246
    v_add_f32 v247, v247, v116
    v_mov_b32 v116, v247
    v_add_f32 v4, v4, v120
    v_mov_b32 v120, v4
    v_add_f32 v5, v5, v124
    v_mov_b32 v124, v5
    v_add_f32 v6, v6, v128
    v_mov_b32 v128, v6
    v_add_f32 v7, v7, v132
    v_mov_b32 v132, v7
    buffer_store_dwordx4 v[244:247], v253, s[96:99], s48 offen sc1
    buffer_store_dwordx4 v[4:7], v253, s[96:99], s48 offen offset:16 sc1
    s_waitcnt vmcnt(0)
    s_nop 0
    v_cvt_pk_bf16_f32 v4, v104, v108
    v_cvt_pk_bf16_f32 v5, v112, v116
    v_cvt_pk_bf16_f32 v6, v120, v124
    v_cvt_pk_bf16_f32 v7, v128, v132
    v_mfma_f32_16x16x32_bf16 v[104:107], v[0:3], v[72:75], 0
    v_mfma_f32_16x16x32_bf16 v[108:111], v[0:3], v[76:79], 0
    v_mfma_f32_16x16x32_bf16 v[112:115], v[0:3], v[80:83], 0
    v_mfma_f32_16x16x32_bf16 v[116:119], v[0:3], v[84:87], 0
    v_mfma_f32_16x16x32_bf16 v[120:123], v[0:3], v[88:91], 0
    v_mfma_f32_16x16x32_bf16 v[124:127], v[0:3], v[92:95], 0
    ds_read_b128 v[244:247], v251
    s_branch L_packx
L_evy:
    s_cmp_lg_u32 s80, 0
    s_cbranch_scc1 L_ev1y
    v_mbcnt_lo_u32_b32 v253, -1, 0
    v_mbcnt_hi_u32_b32 v253, -1, v253
    v_and_b32 v253, 48, v253
    v_add_u32 v251, s63, v253
    s_waitcnt lgkmcnt(0)
    ds_read_b128 v[244:247], v251
    s_barrier
    s_mov_b32 s45, 256
    s_mov_b32 s80, 1
    s_waitcnt lgkmcnt(0)
    s_mov_b32 s44, s55
    s_cmp_ge_u32 s77, 4
    s_cbranch_scc1 L_y
    s_setprio 2
    s_mul_i32 s48, s55, 12
    s_lshr_b32 s48, s48, 4
    s_sub_u32 s58, s55, s48
    s_branch L_y
L_ev1y:
    s_waitcnt vmcnt(8)
    s_cmp_eq_u32 s80, 1
    s_cbranch_scc1 L_ev2y
    s_waitcnt vmcnt(0)
L_ev2y:
    s_mov_b32 s80, 2
    s_mov_b32 s44, 1
    v_perm_b32 v72, v44, v40, s17
    v_perm_b32 v76, v44, v40, s18
    v_perm_b32 v80, v45, v41, s17
    v_perm_b32 v84, v45, v41, s18
    v_perm_b32 v88, v46, v42, s17
    v_perm_b32 v92, v46, v42, s18
    v_perm_b32 v96, v47, v43, s17
    v_perm_b32 v100, v47, v43, s18
    v_perm_b32 v73, v52, v48, s17
    v_perm_b32 v77, v52, v48, s18
    v_perm_b32 v81, v53, v49, s17
    v_perm_b32 v85, v53, v49, s18
    v_perm_b32 v89, v54, v50, s17
    v_perm_b32 v93, v54, v50, s18
    v_perm_b32 v97, v55, v51, s17
    v_perm_b32 v101, v55, v51, s18
    v_perm_b32 v74, v60, v56, s17
    v_perm_b32 v78, v60, v56, s18
    v_perm_b32 v82, v61, v57, s17
    v_perm_b32 v86, v61, v57, s18
    v_perm_b32 v90, v62, v58, s17
    v_perm_b32 v94, v62, v58, s18
    v_perm_b32 v98, v63, v59, s17
    v_perm_b32 v102, v63, v59, s18
    v_perm_b32 v75, v68, v64, s17
    v_perm_b32 v79, v68, v64, s18
    v_perm_b32 v83, v69, v65, s17
    v_perm_b32 v87, v69, v65, s18
    v_perm_b32 v91, v70, v66, s17
    v_perm_b32 v95, v70, v66, s18
    v_perm_b32 v99, v71, v67, s17
    v_perm_b32 v103, v71, v67, s18
    s_waitcnt lgkmcnt(0)
    s_branch L_my
L_lpy:
    s_setprio 0
    s_branch L_lpby
L_againy:
    s_add_u32 s40, s40, 1
    s_mov_b32 s41, s42
    v_readlane_b32 s42, v252, s40
    s_mov_b32 s50, s46
    s_add_u32 s46, s46, 4
    s_min_u32 s42, s42, s38
    s_cmp_ge_u32 s40, s47
    s_cselect_b32 s43, -1, s42
    s_sub_u32 s48, s51, s41
    s_sub_u32 s49, s42, s41
    s_sub_u32 s48, s48, 32
    v_add_u32 v253, s48, v249
    v_add_u32 v254, 4, v253
    v_cmp_gt_u32 vcc, s49, v253
    v_cmp_gt_u32 s[52:53], s49, v254
    s_nop 0
    v_cndmask_b32 v253, 0, v255, vcc
    v_cndmask_b32 v254, 0, v255, s[52:53]
    s_branch L_fy
L_phy:
    s_cmp_eq_u32 s54, 1
    s_cbranch_scc1 L_loop_end
    s_mov_b32 s54, 1
    v_mbcnt_lo_u32_b32 v253, -1, 0
    v_mbcnt_hi_u32_b32 v253, -1, v253
    v_lshlrev_b32 v253, 4, v253
    ds_read_b128 v[72:75], v253 offset:7936
    ds_read_b128 v[76:79], v253 offset:8960
    ds_read_b128 v[80:83], v253 offset:9984
    ds_read_b128 v[84:87], v253 offset:11008
    s_add_u32 s51, s37, 32
    s_mov_b32 s41, s81
    s_sub_u32 s40, s39, 1
    s_max_i32 s48, s40, 0
    v_readlane_b32 s42, v252, s48
    v_readlane_b32 s49, v252, s39
    s_lshl_b32 s48, s37, 4
    v_add_u32 v255, s48, v250
    s_cmp_eq_u32 s39, 0
    s_cselect_b32 s42, 0, s42
    s_cmp_gt_u32 s42, s81
    s_cselect_b32 s42, s42, s49
    s_cselect_b32 s40, s40, s39
    s_cselect_b32 s46, 36, 40
    s_cselect_b32 s76, 1, 0
    s_min_u32 s42, s42, s38
    s_mov_b32 s43, s42
    s_sub_u32 s48, s51, s41
    s_sub_u32 s49, s42, s41
    s_sub_u32 s48, s48, 32
    v_add_u32 v253, s48, v249
    v_add_u32 v254, 4, v253
    v_cmp_gt_u32 vcc, s49, v253
    v_cmp_gt_u32 s[52:53], s49, v254
    s_nop 0
    v_cndmask_b32 v253, 0, v255, vcc
    v_cndmask_b32 v254, 0, v255, s[52:53]
    ds_read_b64_tr_b16 v[240:241], v253
    ds_read_b64_tr_b16 v[242:243], v254 offset:64
    s_waitcnt lgkmcnt(2)
    v_lshlrev_b32 v136, 16, v72
    v_and_b32 v140, s19, v72
    v_lshlrev_b32 v144, 16, v73
    v_and_b32 v148, s19, v73
    v_lshlrev_b32 v152, 16, v74
    v_and_b32 v156, s19, v74
    v_lshlrev_b32 v160, 16, v75
    v_and_b32 v164, s19, v75
    v_lshlrev_b32 v137, 16, v76
    v_and_b32 v141, s19, v76
    v_lshlrev_b32 v145, 16, v77
    v_and_b32 v149, s19, v77
    v_lshlrev_b32 v153, 16, v78
    v_and_b32 v157, s19, v78
    v_lshlrev_b32 v161, 16, v79
    v_and_b32 v165, s19, v79
    v_lshlrev_b32 v138, 16, v80
    v_and_b32 v142, s19, v80
    v_lshlrev_b32 v146, 16, v81
    v_and_b32 v150, s19, v81
    v_lshlrev_b32 v154, 16, v82
    v_and_b32 v158, s19, v82
    v_lshlrev_b32 v162, 16, v83
    v_and_b32 v166, s19, v83
    v_lshlrev_b32 v139, 16, v84
    v_and_b32 v143, s19, v84
    v_lshlrev_b32 v147, 16, v85
    v_and_b32 v151, s19, v85
    v_lshlrev_b32 v155, 16, v86
    v_and_b32 v159, s19, v86
    v_lshlrev_b32 v163, 16, v87
    v_and_b32 v167, s19, v87
    s_cmp_eq_u32 s80, 2
    s_cbranch_scc1 L_x
    buffer_load_dwordx4 v[40:43], v40, s[4:7], s45 offen
    buffer_load_dwordx4 v[44:47], v44, s[4:7], s45 offen
    buffer_load_dwordx4 v[48:51], v48, s[4:7], s45 offen
    buffer_load_dwordx4 v[52:55], v52, s[4:7], s45 offen
    buffer_load_dwordx4 v[56:59], v56, s[4:7], s45 offen
    buffer_load_dwordx4 v[60:63], v60, s[4:7], s45 offen
    buffer_load_dwordx4 v[64:67], v64, s[4:7], s45 offen
    buffer_load_dwordx4 v[68:71], v68, s[4:7], s45 offen
    s_branch L_x
L_accy:
    v_mbcnt_lo_u32_b32 v253, -1, 0
    v_mbcnt_hi_u32_b32 v253, -1, v253
    v_lshlrev_b32 v253, 5, v253
    s_lshl_b32 s48, s79, 3
    s_add_u32 s48, s48, s77
    s_mul_i32 s48, s48, 36864
    s_lshl_b32 s49, s50, 9
    s_add_u32 s48, s48, s49
    s_waitcnt lgkmcnt(0)
    buffer_load_dwordx4 v[244:247], v253, s[96:99], s48 offen sc1
    buffer_load_dwordx4 v[4:7], v253, s[96:99], s48 offen offset:16 sc1
    v_pk_mul_f32 v[104:105], v[104:105], v[136:137]
    v_pk_mul_f32 v[108:109], v[108:109], v[140:141]
    v_pk_mul_f32 v[112:113], v[112:113], v[144:145]
    v_pk_mul_f32 v[116:117], v[116:117], v[148:149]
    v_pk_mul_f32 v[120:121], v[120:121], v[152:153]
    v_pk_mul_f32 v[124:125], v[124:125], v[156:157]
    v_pk_mul_f32 v[128:129], v[128:129], v[160:161]
    v_pk_mul_f32 v[132:133], v[132:133], v[164:165]
    v_pk_fma_f32 v[104:105], v[106:107], v[138:139], v[104:105]
    v_pk_fma_f32 v[108:109], v[110:111], v[142:143], v[108:109]
    v_pk_fma_f32 v[112:113], v[114:115], v[146:147], v[112:113]
    v_pk_fma_f32 v[116:117], v[118:119], v[150:151], v[116:117]
    v_pk_fma_f32 v[120:121], v[122:123], v[154:155], v[120:121]
    v_pk_fma_f32 v[124:125], v[126:127], v[158:159], v[124:125]
    v_pk_fma_f32 v[128:129], v[130:131], v[162:163], v[128:129]
    v_pk_fma_f32 v[132:133], v[134:135], v[166:167], v[132:133]
    v_add_f32 v104, v104, v105
    v_add_f32 v108, v108, v109
    v_add_f32 v112, v112, v113
    v_add_f32 v116, v116, v117
    v_add_f32 v120, v120, v121
    v_add_f32 v124, v124, v125
    v_add_f32 v128, v128, v129
    v_add_f32 v132, v132, v133
    s_waitcnt vmcnt(0)
    v_add_f32 v244, v244, v104
    v_mov_b32 v104, v244
    v_add_f32 v245, v245, v108
    v_mov_b32 v108, v245
    v_add_f32 v246, v246, v112
    v_mov_b32 v112, v246
    v_add_f32 v247, v247, v116
    v_mov_b32 v116, v247
    v_add_f32 v4, v4, v120
    v_mov_b32 v120, v4
    v_add_f32 v5, v5, v124
    v_mov_b32 v124, v5
    v_add_f32 v6, v6, v128
    v_mov_b32 v128, v6
    v_add_f32 v7, v7, v132
    v_mov_b32 v132, v7
    buffer_store_dwordx4 v[244:247], v253, s[96:99], s48 offen sc1
    buffer_store_dwordx4 v[4:7], v253, s[96:99], s48 offen offset:16 sc1
    s_waitcnt vmcnt(0)
    s_nop 0
    v_cvt_pk_bf16_f32 v4, v104, v108
    v_cvt_pk_bf16_f32 v5, v112, v116
    v_cvt_pk_bf16_f32 v6, v120, v124
    v_cvt_pk_bf16_f32 v7, v128, v132
    v_mfma_f32_16x16x32_bf16 v[104:107], v[0:3], v[72:75], 0
    v_mfma_f32_16x16x32_bf16 v[108:111], v[0:3], v[76:79], 0
    v_mfma_f32_16x16x32_bf16 v[112:115], v[0:3], v[80:83], 0
    v_mfma_f32_16x16x32_bf16 v[116:119], v[0:3], v[84:87], 0
    v_mfma_f32_16x16x32_bf16 v[120:123], v[0:3], v[88:91], 0
    v_mfma_f32_16x16x32_bf16 v[124:127], v[0:3], v[92:95], 0
    ds_read_b128 v[244:247], v251
    s_branch L_packy
L_loop_end:
    v_mbcnt_lo_u32_b32 v5, -1, 0
    v_mbcnt_hi_u32_b32 v5, -1, v5
    v_lshl_add_u32 v0, s77, 6, v5
L_loop_done:
    s_setprio 0
    s_cmp_eq_u32 s62, 0
    s_cbranch_scc1 L_fin
    s_add_u32 s36, s36, s61
    v_and_b32 v104, 15, v0
    v_bfe_u32 v105, v0, 4, 2
    v_lshrrev_b32 v106, 3, v104
    v_add_u32 v106, 0, v106
    v_mov_b32 v109, 4
    v_cmp_eq_u32 vcc, v105, v106
    v_cmp_eq_u32 s[28:29], 0, v106
    v_cmp_eq_u32 s[30:31], 0, v105
    v_cndmask_b32 v109, v109, 1, vcc
    v_sub_u32 v107, v106, v105
    v_cndmask_b32 v109, v109, 2, s[28:29]
    s_and_b64 s[32:33], s[28:29], s[30:31]
    v_cndmask_b32 v109, v109, 3, s[30:31]
    v_cmp_eq_u32 vcc, -1, v107
    v_cmp_eq_u32 s[28:29], 2, v107
    v_cndmask_b32 v109, v109, 0, s[32:33]
    s_or_b64 s[28:29], s[28:29], vcc
    v_cmp_eq_u32 vcc, 4, v109
    s_and_b64 vcc, s[28:29], vcc
    v_mov_b32 v107, 0x80008000
    v_lshlrev_b32 v109, 7, v109
    v_cndmask_b32 v108, 0, v107, vcc
    v_and_b32 v107, 7, v104
    v_lshl_add_u32 v109, v107, 4, v109
    global_load_dwordx4 v[8:11], v109, s[64:65] offset:0
    global_load_dwordx4 v[12:15], v109, s[64:65] offset:640
    global_load_dwordx4 v[16:19], v109, s[64:65] offset:1280
    global_load_dwordx4 v[20:23], v109, s[64:65] offset:1920
    s_waitcnt vmcnt(0)
    v_xor_b32 v8, v108, v8
    v_xor_b32 v9, v108, v9
    v_xor_b32 v10, v108, v10
    v_xor_b32 v11, v108, v11
    v_xor_b32 v12, v108, v12
    v_xor_b32 v13, v108, v13
    v_xor_b32 v14, v108, v14
    v_xor_b32 v15, v108, v15
    v_xor_b32 v16, v108, v16
    v_xor_b32 v17, v108, v17
    v_xor_b32 v18, v108, v18
    v_xor_b32 v19, v108, v19
    v_xor_b32 v20, v108, v20
    v_xor_b32 v21, v108, v21
    v_xor_b32 v22, v108, v22
    v_xor_b32 v23, v108, v23
    v_lshlrev_b32 v136, 16, v8
    v_and_b32 v140, s19, v8
    v_lshlrev_b32 v144, 16, v9
    v_and_b32 v148, s19, v9
    v_lshlrev_b32 v152, 16, v10
    v_and_b32 v156, s19, v10
    v_lshlrev_b32 v160, 16, v11
    v_and_b32 v164, s19, v11
    v_lshlrev_b32 v137, 16, v12
    v_and_b32 v141, s19, v12
    v_lshlrev_b32 v145, 16, v13
    v_and_b32 v149, s19, v13
    v_lshlrev_b32 v153, 16, v14
    v_and_b32 v157, s19, v14
    v_lshlrev_b32 v161, 16, v15
    v_and_b32 v165, s19, v15
    v_lshlrev_b32 v138, 16, v16
    v_and_b32 v142, s19, v16
    v_lshlrev_b32 v146, 16, v17
    v_and_b32 v150, s19, v17
    v_lshlrev_b32 v154, 16, v18
    v_and_b32 v158, s19, v18
    v_lshlrev_b32 v162, 16, v19
    v_and_b32 v166, s19, v19
    v_lshlrev_b32 v139, 16, v20
    v_and_b32 v143, s19, v20
    v_lshlrev_b32 v147, 16, v21
    v_and_b32 v151, s19, v21
    v_lshlrev_b32 v155, 16, v22
    v_and_b32 v159, s19, v22
    v_lshlrev_b32 v163, 16, v23
    v_and_b32 v167, s19, v23
    s_branch L_reset
L_restart:
    s_mov_b32 s61, 432
L_reset:
    s_waitcnt vmcnt(0) lgkmcnt(0)
    s_barrier
    v_mov_b32 v8, -1
    v_mov_b32 v9, -1
    v_mov_b32 v10, -1
    v_mov_b32 v11, -1
    v_lshlrev_b32 v6, 4, v0
    v_cmp_gt_u32 vcc, 432, v0
    s_mov_b64 exec, vcc
    ds_write_b128 v6, v[8:11] offset:1024
    s_mov_b64 exec, -1
    v_lshlrev_b32 v6, 2, v5
    v_mov_b32 v4, 0
    ds_write_b32 v6, v4 offset:256
    v_mov_b32 v6, 512
    ds_write_b32 v6, v4
    v_lshrrev_b32 v240, 1, v0
    v_lshlrev_b32 v240, 2, v240
    v_bfe_u32 v2, v0, 1, 5
    v_lshl_add_u32 v2, v2, 3, s77
    v_lshlrev_b32 v2, 11, v2
    s_lshl_b32 s83, s79, 3
    s_add_u32 s83, s83, 13647872
    buffer_load_dwordx2 v[72:73], v2, s[8:11], s83 offen sc1
    s_waitcnt vmcnt(0) lgkmcnt(0)
    s_barrier
    s_branch L_decode
L_fin:
    s_and_b32 s48, s77, 1
    s_lshr_b32 s50, s77, 1
    s_mul_i32 s49, s48, 20480
    s_add_u32 s49, s49, 122688
    v_lshl_add_u32 v6, v5, 4, s49
    s_waitcnt vmcnt(0)
    ds_read_b128 v[8:11], v6 offset:0
    ds_read_b128 v[12:15], v6 offset:1024
    ds_read_b128 v[16:19], v6 offset:2048
    ds_read_b128 v[20:23], v6 offset:3072
    ds_read_b128 v[24:27], v6 offset:4096
    ds_read_b128 v[28:31], v6 offset:5120
    ds_read_b128 v[32:35], v6 offset:6144
    ds_read_b128 v[36:39], v6 offset:7168
    ds_read_b128 v[40:43], v6 offset:8192
    ds_read_b128 v[44:47], v6 offset:9216
    ds_read_b128 v[48:51], v6 offset:10240
    ds_read_b128 v[52:55], v6 offset:11264
    ds_read_b128 v[56:59], v6 offset:12288
    ds_read_b128 v[60:63], v6 offset:13312
    ds_read_b128 v[64:67], v6 offset:14336
    ds_read_b128 v[68:71], v6 offset:15360
    ds_read_b128 v[72:75], v6 offset:16384
    ds_read_b128 v[76:79], v6 offset:17408
    ds_read_b128 v[80:83], v6 offset:18432
    ds_read_b128 v[84:87], v6 offset:19456
    s_mul_i32 s49, s39, 2080
    s_add_u32 s49, s49, 9952
    v_bfe_u32 v7, v0, 4, 2
    v_lshl_add_u32 v7, v7, 9, v248
    v_add_u32 v6, s49, v7
    s_sub_u32 s83, s47, s39
    s_mul_i32 s49, s83, 2080
    v_add_u32 v253, s49, v6
    s_lshl_b32 s49, s77, 11
    s_add_u32 s49, s49, 122688
    v_add_u32 v7, s49, v7
    s_lshl_b32 s49, s77, 2
    v_mov_b32 v254, s49
    s_sub_u32 s49, s47, 1
    s_max_i32 s49, s49, 0
    v_readlane_b32 s42, v252, s49
    s_lshl_b32 s49, s83, 2
    s_set_gpr_idx_on s49, gpr_idx(SRC0)
    v_mov_b32 v104, v168
    v_mov_b32 v105, v169
    v_mov_b32 v106, v170
    v_mov_b32 v107, v171
    v_mov_b32 v108, v204
    v_mov_b32 v109, v205
    v_mov_b32 v110, v206
    v_mov_b32 v111, v207
    s_set_gpr_idx_off
    v_lshlrev_b32 v112, 16, v104
    v_and_b32 v113, s19, v104
    v_lshlrev_b32 v114, 16, v105
    v_and_b32 v115, s19, v105
    v_lshlrev_b32 v116, 16, v106
    v_and_b32 v117, s19, v106
    v_lshlrev_b32 v118, 16, v107
    v_and_b32 v119, s19, v107
    v_lshlrev_b32 v120, 16, v108
    v_and_b32 v121, s19, v108
    v_lshlrev_b32 v122, 16, v109
    v_and_b32 v123, s19, v109
    v_lshlrev_b32 v124, 16, v110
    v_and_b32 v125, s19, v110
    v_lshlrev_b32 v126, 16, v111
    v_and_b32 v127, s19, v111
    v_and_b32 v1, 15, v0
    s_lshl_b32 s50, s50, 4
    v_add_u32 v1, s50, v1
    v_mul_u32_u24 v2, 2080, v1
    v_bfe_u32 v3, v0, 4, 2
    v_lshlrev_b32 v3, 4, v3
    v_add_u32 v2, v2, v3
    s_mul_i32 s49, s79, 49
    v_add_u32 v4, s49, v1
    v_lshl_add_u32 v4, v4, 9, v3
    s_lshl_b32 s48, s48, 6
    v_cmp_gt_u32 s[20:21], 49, v1
    s_mov_b32 s49, 0xbfb8aa3b
    s_waitcnt lgkmcnt(0)
    s_barrier
    s_cmp_eq_u32 s76, 0
    s_cbranch_scc1 L_nocarry
    ds_write_b128 v7, v[168:171] offset:0
    ds_write_b128 v7, v[204:207] offset:256
    ds_write_b32 v254, v7 offset:640
L_nocarry:
    s_cmp_le_u32 s83, 1
    s_cbranch_scc1 L_dumped
    ds_write_b128 v6, v[172:175] offset:2080
    ds_write_b128 v6, v[208:211] offset:2336
    s_cmp_le_u32 s83, 2
    s_cbranch_scc1 L_dumped
    ds_write_b128 v6, v[176:179] offset:4160
    ds_write_b128 v6, v[212:215] offset:4416
    s_cmp_le_u32 s83, 3
    s_cbranch_scc1 L_dumped
    ds_write_b128 v6, v[180:183] offset:6240
    ds_write_b128 v6, v[216:219] offset:6496
    s_cmp_le_u32 s83, 4
    s_cbranch_scc1 L_dumped
    ds_write_b128 v6, v[184:187] offset:8320
    ds_write_b128 v6, v[220:223] offset:8576
    s_cmp_le_u32 s83, 5
    s_cbranch_scc1 L_dumped
    ds_write_b128 v6, v[188:191] offset:10400
    ds_write_b128 v6, v[224:227] offset:10656
    s_cmp_le_u32 s83, 6
    s_cbranch_scc1 L_dumped
    ds_write_b128 v6, v[192:195] offset:12480
    ds_write_b128 v6, v[228:231] offset:12736
    s_cmp_le_u32 s83, 7
    s_cbranch_scc1 L_dumped
    ds_write_b128 v6, v[196:199] offset:14560
    ds_write_b128 v6, v[232:235] offset:14816
L_dumped:
    s_cmp_eq_u32 s83, 0
    s_cbranch_scc1 L_last
    s_cmp_le_u32 s42, s38
    s_cbranch_scc1 L_plain
L_mb:
    ds_read_b32 v128, v254 offset:644
    ds_read_b128 v[104:107], v7 offset:2048
    ds_read_b128 v[108:111], v7 offset:2304
    s_waitcnt lgkmcnt(2)
    v_readfirstlane_b32 s50, v128
    s_cmp_eq_u32 s50, 0
    s_waitcnt lgkmcnt(0)
    s_cbranch_scc1 L_mb
    v_lshlrev_b32 v128, 16, v104
    v_and_b32 v129, s19, v104
    v_pk_add_f32 v[112:113], v[112:113], v[128:129]
    v_cvt_pk_bf16_f32 v104, v112, v113
    v_lshlrev_b32 v130, 16, v105
    v_and_b32 v131, s19, v105
    v_pk_add_f32 v[114:115], v[114:115], v[130:131]
    v_cvt_pk_bf16_f32 v105, v114, v115
    v_lshlrev_b32 v128, 16, v106
    v_and_b32 v129, s19, v106
    v_pk_add_f32 v[116:117], v[116:117], v[128:129]
    v_cvt_pk_bf16_f32 v106, v116, v117
    v_lshlrev_b32 v130, 16, v107
    v_and_b32 v131, s19, v107
    v_pk_add_f32 v[118:119], v[118:119], v[130:131]
    v_cvt_pk_bf16_f32 v107, v118, v119
    v_lshlrev_b32 v128, 16, v108
    v_and_b32 v129, s19, v108
    v_pk_add_f32 v[120:121], v[120:121], v[128:129]
    v_cvt_pk_bf16_f32 v108, v120, v121
    v_lshlrev_b32 v130, 16, v109
    v_and_b32 v131, s19, v109
    v_pk_add_f32 v[122:123], v[122:123], v[130:131]
    v_cvt_pk_bf16_f32 v109, v122, v123
    v_lshlrev_b32 v128, 16, v110
    v_and_b32 v129, s19, v110
    v_pk_add_f32 v[124:125], v[124:125], v[128:129]
    v_cvt_pk_bf16_f32 v110, v124, v125
    v_lshlrev_b32 v130, 16, v111
    v_and_b32 v131, s19, v111
    v_pk_add_f32 v[126:127], v[126:127], v[130:131]
    v_cvt_pk_bf16_f32 v111, v126, v127
L_plain:
    ds_write_b128 v253, v[104:107] offset:0
    ds_write_b128 v253, v[108:111] offset:256
L_last:
    s_waitcnt lgkmcnt(0)
    s_barrier
    s_mov_b64 exec, s[20:21]
    s_cbranch_execz L_end
    ds_read_b128 v[136:139], v2 offset:12032
    ds_read_b128 v[140:143], v2 offset:12096
    ds_read_b128 v[144:147], v2 offset:12672
    ds_read_b128 v[148:151], v2 offset:12736
    ds_read_b128 v[152:155], v2 offset:13312
    ds_read_b128 v[156:159], v2 offset:13376
    ds_read_b128 v[160:163], v2 offset:13952
    ds_read_b128 v[164:167], v2 offset:14016
    ds_read_b128 v[168:171], v2 offset:12544
    ds_read_b128 v[172:175], v2 offset:12608
    ds_read_b128 v[176:179], v2 offset:12160
    ds_read_b128 v[180:183], v2 offset:12224
    ds_read_b128 v[184:187], v2 offset:13440
    ds_read_b128 v[188:191], v2 offset:13504
    s_waitcnt lgkmcnt(13)
    v_mfma_f32_16x16x32_bf16 v[104:107], v[8:11], v[136:139], 0
    ds_read_b128 v[192:195], v2 offset:13824
    v_mfma_f32_16x16x32_bf16 v[108:111], v[12:15], v[136:139], 0
    s_waitcnt lgkmcnt(13)
    v_mfma_f32_16x16x32_bf16 v[104:107], v[16:19], v[140:143], v[104:107]
    ds_read_b128 v[196:199], v2 offset:13888
    v_mfma_f32_16x16x32_bf16 v[108:111], v[20:23], v[140:143], v[108:111]
    s_waitcnt lgkmcnt(13)
    v_mfma_f32_16x16x32_bf16 v[104:107], v[24:27], v[144:147], v[104:107]
    ds_read_b128 v[200:203], v2 offset:13056
    v_mfma_f32_16x16x32_bf16 v[108:111], v[28:31], v[144:147], v[108:111]
    s_waitcnt lgkmcnt(13)
    v_mfma_f32_16x16x32_bf16 v[104:107], v[32:35], v[148:151], v[104:107]
    ds_read_b128 v[204:207], v2 offset:13120
    v_mfma_f32_16x16x32_bf16 v[108:111], v[36:39], v[148:151], v[108:111]
    s_waitcnt lgkmcnt(13)
    v_mfma_f32_16x16x32_bf16 v[104:107], v[24:27], v[152:155], v[104:107]
    ds_read_b128 v[208:211], v2 offset:12288
    v_mfma_f32_16x16x32_bf16 v[108:111], v[28:31], v[152:155], v[108:111]
    s_waitcnt lgkmcnt(13)
    v_mfma_f32_16x16x32_bf16 v[104:107], v[32:35], v[156:159], v[104:107]
    ds_read_b128 v[212:215], v2 offset:12352
    v_mfma_f32_16x16x32_bf16 v[108:111], v[36:39], v[156:159], v[108:111]
    s_waitcnt lgkmcnt(13)
    v_mfma_f32_16x16x32_bf16 v[104:107], v[24:27], v[160:163], v[104:107]
    ds_read_b128 v[216:219], v2 offset:13696
    v_mfma_f32_16x16x32_bf16 v[108:111], v[28:31], v[160:163], v[108:111]
    s_waitcnt lgkmcnt(13)
    v_mfma_f32_16x16x32_bf16 v[104:107], v[32:35], v[164:167], v[104:107]
    ds_read_b128 v[220:223], v2 offset:13760
    v_mfma_f32_16x16x32_bf16 v[108:111], v[36:39], v[164:167], v[108:111]
    s_waitcnt lgkmcnt(6)
    ds_read_b128 v[224:227], v2 offset:12928
    ds_read_b128 v[228:231], v2 offset:12992
    ds_read_b128 v[136:139], v2 offset:13568
    ds_read_b128 v[140:143], v2 offset:13632
    ds_read_b128 v[144:147], v2 offset:12416
    ds_read_b128 v[148:151], v2 offset:12480
    ds_read_b128 v[152:155], v2 offset:12800
    ds_read_b128 v[156:159], v2 offset:12864
    ds_read_b128 v[160:163], v2 offset:13184
    ds_read_b128 v[164:167], v2 offset:13248
    v_mfma_f32_16x16x32_bf16 v[112:115], v[40:43], v[168:171], 0
    s_nop 0
    s_nop 0
    v_mul_f32 v88, s49, v104
    v_mfma_f32_16x16x32_bf16 v[116:119], v[44:47], v[168:171], 0
    v_mul_f32 v89, s49, v105
    v_mul_f32 v90, s49, v106
    v_mfma_f32_16x16x32_bf16 v[112:115], v[48:51], v[172:175], v[112:115]
    v_mul_f32 v91, s49, v107
    v_mul_f32 v92, s49, v108
    v_mul_f32 v93, s49, v109
    v_mfma_f32_16x16x32_bf16 v[116:119], v[52:55], v[172:175], v[116:119]
    v_mul_f32 v94, s49, v110
    v_mul_f32 v95, s49, v111
    v_mfma_f32_16x16x32_bf16 v[112:115], v[56:59], v[176:179], v[112:115]
    v_exp_f32 v88, v88
    v_exp_f32 v89, v89
    v_exp_f32 v90, v90
    v_mfma_f32_16x16x32_bf16 v[116:119], v[60:63], v[176:179], v[116:119]
    v_exp_f32 v91, v91
    v_exp_f32 v92, v92
    v_mfma_f32_16x16x32_bf16 v[112:115], v[64:67], v[180:183], v[112:115]
    v_exp_f32 v93, v93
    v_exp_f32 v94, v94
    v_exp_f32 v95, v95
    v_mfma_f32_16x16x32_bf16 v[116:119], v[68:71], v[180:183], v[116:119]
    v_cvt_pk_bf16_f32 v96, v104, v105
    v_cvt_pk_bf16_f32 v97, v106, v107
    v_mfma_f32_16x16x32_bf16 v[112:115], v[72:75], v[184:187], v[112:115]
    v_cvt_pk_bf16_f32 v98, v108, v109
    v_cvt_pk_bf16_f32 v99, v110, v111
    v_mfma_f32_16x16x32_bf16 v[116:119], v[76:79], v[184:187], v[116:119]
    buffer_store_dwordx4 v[96:99], v4, s[12:15], s48 offen offset:0 nt
    v_add_f32 v88, 1.0, v88
    v_add_f32 v89, 1.0, v89
    v_mfma_f32_16x16x32_bf16 v[112:115], v[80:83], v[188:191], v[112:115]
    v_add_f32 v90, 1.0, v90
    v_add_f32 v91, 1.0, v91
    v_mfma_f32_16x16x32_bf16 v[116:119], v[84:87], v[188:191], v[116:119]
    v_add_f32 v92, 1.0, v92
    v_add_f32 v93, 1.0, v93
    v_add_f32 v94, 1.0, v94
    v_mfma_f32_16x16x32_bf16 v[112:115], v[72:75], v[192:195], v[112:115]
    v_add_f32 v95, 1.0, v95
    v_rcp_f32 v88, v88
    v_mfma_f32_16x16x32_bf16 v[116:119], v[76:79], v[192:195], v[116:119]
    v_rcp_f32 v89, v89
    v_rcp_f32 v90, v90
    v_rcp_f32 v91, v91
    v_mfma_f32_16x16x32_bf16 v[112:115], v[80:83], v[196:199], v[112:115]
    v_rcp_f32 v92, v92
    v_rcp_f32 v93, v93
    v_mfma_f32_16x16x32_bf16 v[116:119], v[84:87], v[196:199], v[116:119]
    v_rcp_f32 v94, v94
    v_rcp_f32 v95, v95
    s_waitcnt lgkmcnt(8)
    v_mfma_f32_16x16x32_bf16 v[120:123], v[40:43], v[200:203], 0
    s_nop 0
    v_mfma_f32_16x16x32_bf16 v[124:127], v[44:47], v[200:203], 0
    s_nop 0
    v_mfma_f32_16x16x32_bf16 v[120:123], v[48:51], v[204:207], v[120:123]
    s_nop 0
    v_mfma_f32_16x16x32_bf16 v[124:127], v[52:55], v[204:207], v[124:127]
    v_mul_f32 v112, v112, v88
    v_mfma_f32_16x16x32_bf16 v[120:123], v[56:59], v[208:211], v[120:123]
    v_mul_f32 v113, v113, v89
    v_mfma_f32_16x16x32_bf16 v[124:127], v[60:63], v[208:211], v[124:127]
    v_mul_f32 v114, v114, v90
    v_mfma_f32_16x16x32_bf16 v[120:123], v[64:67], v[212:215], v[120:123]
    v_mul_f32 v115, v115, v91
    v_mfma_f32_16x16x32_bf16 v[124:127], v[68:71], v[212:215], v[124:127]
    v_mul_f32 v116, v116, v92
    v_mfma_f32_16x16x32_bf16 v[120:123], v[72:75], v[216:219], v[120:123]
    v_mul_f32 v117, v117, v93
    v_mfma_f32_16x16x32_bf16 v[124:127], v[76:79], v[216:219], v[124:127]
    v_mul_f32 v118, v118, v94
    v_mfma_f32_16x16x32_bf16 v[120:123], v[80:83], v[220:223], v[120:123]
    v_mul_f32 v119, v119, v95
    v_mfma_f32_16x16x32_bf16 v[124:127], v[84:87], v[220:223], v[124:127]
    v_cvt_pk_bf16_f32 v100, v112, v113
    v_mfma_f32_16x16x32_bf16 v[120:123], v[72:75], v[224:227], v[120:123]
    v_cvt_pk_bf16_f32 v101, v114, v115
    v_mfma_f32_16x16x32_bf16 v[124:127], v[76:79], v[224:227], v[124:127]
    v_cvt_pk_bf16_f32 v102, v116, v117
    v_mfma_f32_16x16x32_bf16 v[120:123], v[80:83], v[228:231], v[120:123]
    v_cvt_pk_bf16_f32 v103, v118, v119
    v_mfma_f32_16x16x32_bf16 v[124:127], v[84:87], v[228:231], v[124:127]
    buffer_store_dwordx4 v[100:103], v4, s[12:15], s48 offen offset:128 nt
    s_waitcnt lgkmcnt(0)
    v_mfma_f32_16x16x32_bf16 v[128:131], v[40:43], v[136:139], 0
    s_nop 0
    v_mfma_f32_16x16x32_bf16 v[132:135], v[44:47], v[136:139], 0
    s_nop 0
    v_mfma_f32_16x16x32_bf16 v[128:131], v[48:51], v[140:143], v[128:131]
    s_nop 0
    v_mfma_f32_16x16x32_bf16 v[132:135], v[52:55], v[140:143], v[132:135]
    v_mul_f32 v120, v120, v88
    v_mfma_f32_16x16x32_bf16 v[128:131], v[56:59], v[144:147], v[128:131]
    v_mul_f32 v121, v121, v89
    v_mfma_f32_16x16x32_bf16 v[132:135], v[60:63], v[144:147], v[132:135]
    v_mul_f32 v122, v122, v90
    v_mfma_f32_16x16x32_bf16 v[128:131], v[64:67], v[148:151], v[128:131]
    v_mul_f32 v123, v123, v91
    v_mfma_f32_16x16x32_bf16 v[132:135], v[68:71], v[148:151], v[132:135]
    v_mul_f32 v124, v124, v92
    v_mfma_f32_16x16x32_bf16 v[128:131], v[72:75], v[152:155], v[128:131]
    v_mul_f32 v125, v125, v93
    v_mfma_f32_16x16x32_bf16 v[132:135], v[76:79], v[152:155], v[132:135]
    v_mul_f32 v126, v126, v94
    v_mfma_f32_16x16x32_bf16 v[128:131], v[80:83], v[156:159], v[128:131]
    v_mul_f32 v127, v127, v95
    v_mfma_f32_16x16x32_bf16 v[132:135], v[84:87], v[156:159], v[132:135]
    v_cvt_pk_bf16_f32 v96, v120, v121
    v_mfma_f32_16x16x32_bf16 v[128:131], v[72:75], v[160:163], v[128:131]
    v_cvt_pk_bf16_f32 v97, v122, v123
    v_mfma_f32_16x16x32_bf16 v[132:135], v[76:79], v[160:163], v[132:135]
    v_cvt_pk_bf16_f32 v98, v124, v125
    v_mfma_f32_16x16x32_bf16 v[128:131], v[80:83], v[164:167], v[128:131]
    v_cvt_pk_bf16_f32 v99, v126, v127
    v_mfma_f32_16x16x32_bf16 v[132:135], v[84:87], v[164:167], v[132:135]
    buffer_store_dwordx4 v[96:99], v4, s[12:15], s48 offen offset:256 nt
    s_nop 4
    v_mul_f32 v128, v128, v88
    v_mul_f32 v129, v129, v89
    v_mul_f32 v130, v130, v90
    v_mul_f32 v131, v131, v91
    v_mul_f32 v132, v132, v92
    v_mul_f32 v133, v133, v93
    v_mul_f32 v134, v134, v94
    v_mul_f32 v135, v135, v95
    v_cvt_pk_bf16_f32 v100, v128, v129
    v_cvt_pk_bf16_f32 v101, v130, v131
    v_cvt_pk_bf16_f32 v102, v132, v133
    v_cvt_pk_bf16_f32 v103, v134, v135
    buffer_store_dwordx4 v[100:103], v4, s[12:15], s48 offen offset:384 nt
L_end:
L_exit:
    s_endpgm
.section .rodata,"a"
.p2align 6
.amdhsa_kernel gather_scatter__tensor_product_equiv_equiformer__graph_kernel
  .amdhsa_next_free_vgpr 256
  .amdhsa_next_free_sgpr 102
  .amdhsa_accum_offset 256
  .amdhsa_group_segment_fixed_size 0
  .amdhsa_kernarg_size 96
  .amdhsa_user_sgpr_count 2
  .amdhsa_user_sgpr_kernarg_segment_ptr 1
  .amdhsa_system_sgpr_workgroup_id_x 1
.end_amdhsa_kernel
```
